```python
import torch

def _softmax(x, axis=-1):
    return torch.softmax(x, dim=axis)

def _gelu(x):
    return torch.nn.functional.gelu(x, approximate='tanh')

def _silu(x):
    return torch.nn.functional.silu(x)

def _sigmoid(x):
    return torch.sigmoid(x)

def _layernorm(x, axis=-1, eps=1e-05):
    m = x.mean(dim=axis, keepdim=True)
    v = x.var(dim=axis, keepdim=True, unbiased=False)
    return (x - m) / torch.sqrt(v + eps)

def _scatter_add(tgt, idx, src, axis=0):
    return tgt.clone().index_add_(axis, idx, src)

def _segment_sum(src, seg, n):
    out = torch.zeros((n,) + src.shape[1:], dtype=src.dtype)
    return out.index_add_(0, seg, src)

def _pad(x, pw):
    flat = tuple((v for pair in reversed(pw) for v in pair))
    return torch.nn.functional.pad(x, flat)
kernel_name = 'adaLN_cond__sliding_local_dilated__glu_gated_bilinear__prompt'

def setup_inputs():

    _w = lambda a: (lambda t: t.to(torch.bfloat16) if t.is_floating_point() else t)(torch.as_tensor(a))

    def _A_setup():
        B, S, D = (1, 2048, 512)
        return {'x': _w((lambda *s: torch.randn(*s, dtype=torch.bfloat16) * 0.05)(B, S, D)), 'wqkv': _w((lambda *s: torch.randn(*s, dtype=torch.bfloat16) * 0.05)(D, 3 * D)), 'wo': _w((lambda *s: torch.randn(*s, dtype=torch.bfloat16) * 0.05)(D, D))}
    _A_in = _A_setup()

    def _B_setup():
        B, S, D, F = (1, 2048, 512, 1792)
        return {'x': _w((lambda *s: torch.randn(*s, dtype=torch.bfloat16) * 0.05)(B, S, D)), 'w_gate': _w((lambda *s: torch.randn(*s, dtype=torch.bfloat16) * 0.8)(D, F) * D ** (-0.5)), 'w_up': _w((lambda *s: torch.randn(*s, dtype=torch.bfloat16) * 0.8)(D, F) * D ** (-0.5)), 'w_down': _w((lambda *s: torch.randn(*s, dtype=torch.bfloat16) * 0.8)(F, D) * F ** (-0.5))}
    _B_in = _B_setup()
    return {'A_x': _A_in['x'], 'A_wqkv': _A_in['wqkv'], 'A_wo': _A_in['wo'], 'B_x': _B_in['x'], 'B_w_gate': _B_in['w_gate'], 'B_w_up': _B_in['w_up'], 'B_w_down': _B_in['w_down'], 'c': _w((lambda *s: torch.randn(*s, dtype=torch.bfloat16) * 0.1)(1, 512) * 8.0), 'w_mod': _w((lambda *s: torch.randn(*s, dtype=torch.bfloat16) * 0.1)(512, 6 * 512) * 512 ** (-0.5) * 8.0)}

def reference(A_x, A_wqkv, A_wo, B_x, B_w_gate, B_w_up, B_w_down, c, w_mod):

    def _A_ref(x, wqkv, wo):
        B, S, D = x.shape
        H = 32
        Dh = D // H
        W, dil = (8, 2)
        qkv = (lambda x, *d: x.permute(*d))((x @ wqkv).reshape(B, S, 3, H, Dh), 2, 0, 3, 1, 4)
        q, k, v = (qkv[0], qkv[1], qkv[2])
        scale = Dh ** (-0.5)
        pos = torch.arange(S)
        off = torch.arange(W) * dil
        idx = pos[:, None] - off[None, :]
        mask = idx >= 0
        idx_c = torch.where(mask, idx, 0).reshape(-1)
        kg = k[:, :, idx_c, :].reshape(B, H, S, W, Dh)
        vg = v[:, :, idx_c, :].reshape(B, H, S, W, Dh)
        logits = torch.einsum('bhsd,bhswd->bhsw', q, kg) * scale
        logits = torch.where(mask[None, None, :, :], logits, -1000000000.0)
        attn = _softmax(logits, axis=-1)
        o = torch.einsum('bhsw,bhswd->bhsd', attn, vg)
        return (lambda x, *d: x.permute(*d))(o, 0, 2, 1, 3).reshape(B, S, D) @ wo

    def _B_ref(x, w_gate, w_up, w_down):
        g = torch.einsum('bsd,df->bsf', x, w_gate)
        u = torch.einsum('bsd,df->bsf', x, w_up)
        h = g * u
        return torch.einsum('bsf,fd->bsd', h, w_down)
    x = A_x
    mod = (_silu(c) @ w_mod).reshape(c.shape[0], 6, 1, -1)
    sa, ca, ga, sb, cb, gb = (mod[:, 0].clone(), mod[:, 1].clone(), mod[:, 2].clone(), mod[:, 3].clone(), mod[:, 4].clone(), mod[:, 5].clone())
    h = _layernorm(x, axis=-1) * (1 + ca) + sa
    x = x + ga * _A_ref(h, A_wqkv, A_wo)
    h = _layernorm(x, axis=-1) * (1 + cb) + sb
    x = x + gb * _B_ref(h, B_w_gate, B_w_up, B_w_down)
    return x
```

```asm
; @launch grid=(256,1,1) block=(512,1,1) lds=163840
.amdgcn_target "amdgcn-amd-amdhsa--gfx950"
.text
.globl adaLN_cond__sliding_local_dilated__glu_gated_bilinear__prompt_kernel
.p2align 12
.p2align 8
.type adaLN_cond__sliding_local_dilated__glu_gated_bilinear__prompt_kernel,@function
adaLN_cond__sliding_local_dilated__glu_gated_bilinear__prompt_kernel:
    s_cmp_ge_u32 s2, 256
    s_cbranch_scc1 L_end
    s_load_dwordx16 s[8:23], s[0:1], 0
    s_load_dwordx8 s[24:31], s[0:1], 64
    v_and_b32 v1, 63, v0
    v_lshrrev_b32 v2, 6, v0
    s_lshr_b32 s77, s2, 3
    v_readfirstlane_b32 s3, v2
    v_lshrrev_b32 v4, 3, v1
    v_and_b32 v5, 7, v1
    v_lshrrev_b32 v6, 4, v1
    v_mov_b32 v12, 0
    s_cmp_ge_u32 s3, 4
    s_cbranch_scc1 L_h0
    v_lshrrev_b32 v2, 5, v1
    v_and_b32 v7, 31, v1
    v_lshlrev_b32 v7, 4, v7
    v_lshl_add_u32 v7, v2, 10, v7
    s_lshr_b32 s80, s2, 1
    s_and_b32 s80, s80, 3
    s_lshl_b32 s80, s80, 3
    s_lshr_b32 s88, s77, 2
    s_add_u32 s80, s80, s88
    s_lshl_b32 s91, s80, 6
    s_lshl_b32 s88, s3, 1
    s_add_u32 s91, s91, s88
    s_sub_u32 s91, s91, 16
    v_mov_b32 v3, 0
    v_mov_b32 v224, 0
    s_cmp_ge_u32 s2, 64
    s_cbranch_scc1 L_nmod0
    v_lshlrev_b32 v2, 1, v6
    v_xor_b32 v2, v2, v5
    v_mul_u32_u24 v3, 6144, v4
    v_lshl_add_u32 v3, v2, 4, v3
    s_min_u32 s78, s2, 191
    s_lshr_b32 s79, s78, 2
    s_and_b32 s88, s78, 3
    s_lshl_b32 s76, s88, 7
    s_lshl_b32 s78, s3, 5
    s_add_u32 s76, s76, s78
    s_mul_i32 s76, s76, 6144
    s_lshl_b32 s78, s79, 7
    s_add_u32 s69, s76, s78
    v_and_b32 v13, 127, v0
    s_lshl_b32 s78, s88, 7
    v_add_lshl_u32 v224, v13, s78, 1
    s_lshl_b32 s70, s79, 8
    s_lshl_b32 s78, s3, 6
    s_add_u32 s70, s70, s78
    s_mul_i32 s78, s88, 12288
    s_add_u32 s70, s70, s78
    s_add_u32 s70, s70, 65536
    s_waitcnt lgkmcnt(0)
    s_mov_b32 s56, s24
    s_mov_b32 s57, s25
    s_mov_b32 s58, 0x300000
    s_mov_b32 s59, 0x20000
    s_lshl_b32 s78, s3, 12
    s_add_u32 m0, s78, 8192
    s_add_u32 s76, s69, 0
    buffer_load_dwordx4 v3, s[56:59], s76 offen lds
    s_add_u32 m0, s78, 9216
    s_add_u32 s76, s69, 49152
    buffer_load_dwordx4 v3, s[56:59], s76 offen lds
    s_add_u32 m0, s78, 10240
    s_add_u32 s76, s69, 98304
    buffer_load_dwordx4 v3, s[56:59], s76 offen lds
    s_add_u32 m0, s78, 11264
    s_add_u32 s76, s69, 147456
    buffer_load_dwordx4 v3, s[56:59], s76 offen lds
    global_load_ushort v224, v224, s[22:23]
    global_load_dword v225, v12, s[30:31] sc1
L_nmod0:
    s_waitcnt lgkmcnt(0)
    s_mov_b32 s14, s80
    s_mov_b32 s29, s91
    s_mov_b32 s32, s8
    s_mov_b32 s33, s9
    s_mov_b32 s34, 0x200000
    s_mov_b32 s35, 0x20000
    s_max_i32 s78, s29, 0
    s_lshl_b32 s78, s78, 10
    buffer_load_dwordx4 v[16:19], v7, s[32:35], s78 offen offset:0
    buffer_load_dwordx4 v[20:23], v7, s[32:35], s78 offen offset:512
    s_cmp_lt_u32 s2, 64
    s_cbranch_scc1 L_nmod0b
    global_load_dword v225, v12, s[30:31] sc1
L_nmod0b:
    v_mov_b32 v228, 0
    s_cmp_ge_u32 s2, 64
    s_cbranch_scc1 L_mod1x
    v_and_b32 v13, 127, v0
    v_lshrrev_b32 v226, 5, v13
    v_lshlrev_b32 v226, 6, v226
    v_bfe_u32 v14, v13, 2, 2
    v_lshl_add_u32 v226, v14, 4, v226
    v_and_b32 v14, 3, v13
    v_lshl_add_u32 v226, v14, 1, v226
    v_bfe_u32 v14, v13, 4, 1
    v_lshl_add_u32 v226, v14, 3, v226
    v_and_b32 v2, 15, v1
    v_lshrrev_b32 v228, 2, v2
    v_and_b32 v227, 1, v6
    v_lshl_add_u32 v228, v227, 2, v228
    v_bfe_u32 v227, v2, 1, 1
    s_lshl_b32 s76, s3, 1
    v_or_b32 v227, s76, v227
    v_and_b32 v14, 6, v228
    v_xor_b32 v227, v227, v14
    v_lshlrev_b32 v227, 4, v227
    v_lshl_add_u32 v227, v228, 7, v227
    v_and_b32 v14, 1, v2
    v_lshl_add_u32 v227, v14, 3, v227
    v_lshrrev_b32 v14, 1, v6
    v_lshl_add_u32 v227, v14, 10, v227
    v_lshlrev_b32 v228, 4, v6
    v_add_u32 v227, 8192, v227
    s_mov_b32 s60, s30
    s_mov_b32 s61, s31
    s_mov_b32 s62, 0xc00000
    s_mov_b32 s63, 0x20000
    s_waitcnt vmcnt(2)
    v_lshlrev_b32 v224, 16, v224
    v_mul_f32 v14, 0xbfb8aa3b, v224
    v_exp_f32 v14, v14
    s_nop 0
    v_add_f32 v14, 1.0, v14
    v_rcp_f32 v14, v14
    s_nop 0
    v_mul_f32 v224, v224, v14
    v_cvt_pk_bf16_f32 v224, v224, v224
    ds_write_b16 v226, v224 offset:4096
    v_readfirstlane_b32 s76, v225
    s_nop 0
    s_mul_i32 s77, s76, 0x9E3779B1
    s_lshr_b32 s78, s77, 15
    s_xor_b32 s77, s77, s78
    s_or_b32 s77, s77, 0x01010101
    s_xor_b32 s68, s76, s77
    s_waitcnt lgkmcnt(0)
    s_barrier
    ds_read_b64_tr_b16 v[144:145], v227 offset:0
    ds_read_b64_tr_b16 v[146:147], v227 offset:2048
    ds_read_b128 v[160:163], v228 offset:4096
    ds_read_b64_tr_b16 v[148:149], v227 offset:4096
    ds_read_b64_tr_b16 v[150:151], v227 offset:6144
    ds_read_b128 v[164:167], v228 offset:4160
    ds_read_b64_tr_b16 v[152:153], v227 offset:8192
    ds_read_b64_tr_b16 v[154:155], v227 offset:10240
    ds_read_b128 v[168:171], v228 offset:4224
    ds_read_b64_tr_b16 v[156:157], v227 offset:12288
    ds_read_b64_tr_b16 v[158:159], v227 offset:14336
    ds_read_b128 v[172:175], v228 offset:4288
    v_mov_b32 v14, 0xffffff00
    s_waitcnt lgkmcnt(9)
    v_mfma_f32_16x16x32_bf16 v[232:235], v[144:147], v[160:163], 0
    s_waitcnt lgkmcnt(6)
    v_mfma_f32_16x16x32_bf16 v[232:235], v[148:151], v[164:167], v[232:235]
    s_waitcnt lgkmcnt(3)
    v_mfma_f32_16x16x32_bf16 v[232:235], v[152:155], v[168:171], v[232:235]
    s_waitcnt lgkmcnt(0)
    v_mfma_f32_16x16x32_bf16 v[232:235], v[156:159], v[172:175], v[232:235]
    s_nop 6
    s_bfe_u32 s76, s68, 0x80000
    v_and_or_b32 v232, v232, v14, s76
    s_bfe_u32 s76, s68, 0x80008
    v_and_or_b32 v233, v233, v14, s76
    s_bfe_u32 s76, s68, 0x80010
    v_and_or_b32 v234, v234, v14, s76
    s_bfe_u32 s76, s68, 0x80018
    v_and_or_b32 v235, v235, v14, s76
    s_mov_b32 exec_lo, 0x00010001
    s_mov_b32 exec_hi, 0x00010001
    buffer_store_dwordx4 v[232:235], v228, s[60:63], s70 offen sc1
    s_mov_b64 exec, -1
L_mod1x:
    s_mov_b32 s14, s80
    s_and_b32 s15, s2, 1
    s_lshl_b32 s15, s15, 2
    s_bfe_u32 s88, s2, 0x20003
    s_add_u32 s15, s15, s88
    s_and_b32 s76, s2, 7
    s_lshr_b32 s77, s2, 3
    s_lshr_b32 s78, s77, 4
    s_lshl_b32 s4, s76, 1
    s_add_u32 s4, s4, s78
    s_and_b32 s5, s77, 15
    s_lshr_b32 s73, s5, 3
    s_and_b32 s7, s5, 7
    s_lshl_b32 s6, s4, 1
    s_add_u32 s6, s6, s73
    s_and_b32 s74, s3, 3
    s_lshl_b32 s89, s4, 11
    s_add_u32 s89, s89, 4096
    s_mov_b32 s88, 8192
    s_mov_b32 s60, s30
    s_mov_b32 s61, s31
    s_mov_b32 s62, 0xc00000
    s_mov_b32 s63, 0x20000
    s_mov_b32 s36, s10
    s_mov_b32 s37, s11
    s_mov_b32 s38, 0x180000
    s_mov_b32 s39, 0x20000
    s_mov_b32 s40, s12
    s_mov_b32 s41, s13
    s_mov_b32 s42, 0x80000
    s_mov_b32 s43, 0x20000
    s_mov_b32 s44, s16
    s_mov_b32 s45, s17
    s_mov_b32 s46, 0x1c0000
    s_mov_b32 s47, 0x20000
    s_mov_b32 s48, s18
    s_mov_b32 s49, s19
    s_mov_b32 s50, 0x1c0000
    s_mov_b32 s51, 0x20000
    s_mov_b32 s52, s20
    s_mov_b32 s53, s21
    s_mov_b32 s54, 0x1c0000
    s_mov_b32 s55, 0x20000
    s_mov_b32 s64, s26
    s_mov_b32 s65, s27
    s_mov_b32 s66, 0x200000
    s_mov_b32 s67, 0x20000
    s_and_b32 s72, s14, 7
    s_lshl_b32 s72, s72, 1
    v_lshrrev_b32 v2, 5, v1
    s_lshl_b32 s76, s3, 1
    v_add_u32 v2, s76, v2
    s_lshl_b32 s76, s72, 2
    v_and_b32 v14, 31, v1
    v_subrev_u32 v14, s76, v14
    v_and_b32 v14, 63, v14
    v_and_b32 v15, 15, v14
    v_xor_b32 v15, v15, v2
    v_lshlrev_b32 v15, 4, v15
    v_lshl_add_u32 v10, v2, 8, v15
    v_lshrrev_b32 v15, 4, v14
    v_mul_u32_u24 v15, 20480, v15
    v_add3_u32 v10, v10, v15, s88
    v_xor_b32 v14, 32, v14
    v_and_b32 v15, 15, v14
    v_xor_b32 v15, v15, v2
    v_lshlrev_b32 v15, 4, v15
    v_lshl_add_u32 v229, v2, 8, v15
    v_lshrrev_b32 v15, 4, v14
    v_mul_u32_u24 v15, 20480, v15
    v_add3_u32 v229, v229, v15, s88
    v_and_b32 v11, 31, v1
    v_lshlrev_b32 v11, 5, v11
    v_lshlrev_b32 v8, 4, v1
    v_and_b32 v2, 1, v6
    v_lshlrev_b32 v2, 1, v2
    s_and_b32 s76, s3, 1
    s_lshl_b32 s76, s76, 2
    v_or_b32 v2, s76, v2
    v_xor_b32 v2, v2, v5
    v_mul_u32_u24 v9, 3072, v4
    v_lshl_add_u32 v9, v2, 4, v9
    s_mul_i32 s90, s74, 24576
    s_lshl_b32 s76, s15, 7
    s_add_u32 s90, s90, s76
    s_lshl_b32 s91, s74, 10
    s_add_u32 s91, s91, 90112
    s_mul_i32 s72, s72, 98304
    v_and_b32 v2, 15, v1
    v_add_u32 v14, 0, v6
    v_xor_b32 v14, v14, v2
    v_lshlrev_b32 v14, 4, v14
    v_lshl_add_u32 v200, v2, 8, v14
    v_add_u32 v204, 40960, v200
    v_add_u32 v14, 4, v6
    v_xor_b32 v14, v14, v2
    v_lshlrev_b32 v14, 4, v14
    v_lshl_add_u32 v201, v2, 8, v14
    v_add_u32 v205, 40960, v201
    v_add_u32 v14, 8, v6
    v_xor_b32 v14, v14, v2
    v_lshlrev_b32 v14, 4, v14
    v_lshl_add_u32 v202, v2, 8, v14
    v_add_u32 v206, 40960, v202
    v_add_u32 v14, 12, v6
    v_xor_b32 v14, v14, v2
    v_lshlrev_b32 v14, 4, v14
    v_lshl_add_u32 v203, v2, 8, v14
    v_add_u32 v207, 40960, v203
    v_bfe_u32 v14, v2, 1, 1
    s_lshl_b32 s76, s3, 1
    v_or_b32 v14, s76, v14
    v_lshrrev_b32 v15, 3, v2
    v_lshlrev_b32 v15, 1, v15
    v_xor_b32 v14, v14, v15
    v_and_b32 v15, 1, v6
    v_lshlrev_b32 v15, 2, v15
    v_xor_b32 v14, v14, v15
    v_lshlrev_b32 v14, 4, v14
    v_lshrrev_b32 v15, 2, v2
    v_lshl_add_u32 v14, v15, 7, v14
    v_and_b32 v15, 1, v2
    v_lshl_add_u32 v14, v15, 3, v14
    v_lshl_add_u32 v14, v6, 10, v14
    v_add_u32 v208, 90112, v14
    v_add_u32 v209, 126976, v14
    s_mov_b32 s82, 0xaaaaaaaa
    s_mov_b32 s83, 0xaaaaaaaa
    v_and_b32 v15, 1, v2
    v_lshl_add_u32 v14, v6, 2, v15
    v_cmp_le_u32 s[84:85], v14, v2
    v_add_u32 v14, 2, v14
    v_cmp_le_u32 s[86:87], v14, v2
    v_mov_b32 v12, 0x0c0c0c0c
    v_mov_b32 v14, 0xc0c0100
    v_mov_b32 v15, 0x1000c0c
    v_cndmask_b32 v14, v14, v15, s[82:83]
    v_cndmask_b32 v210, v14, v12, s[84:85]
    v_cndmask_b32 v212, v12, v14, s[84:85]
    v_mov_b32 v14, 0xc0c0302
    v_mov_b32 v15, 0x3020c0c
    v_cndmask_b32 v14, v14, v15, s[82:83]
    v_cndmask_b32 v211, v14, v12, s[86:87]
    v_cndmask_b32 v213, v12, v14, s[86:87]
    v_mov_b32 v214, 0x3f803f80
    v_mov_b32 v215, 0x3f803f80
    v_mov_b32 v216, 0x3f803f80
    v_mov_b32 v217, 0x3f803f80
    v_and_b32 v14, 1, v6
    v_lshl_add_u32 v14, v14, 5, v2
    v_lshrrev_b32 v15, 5, v1
    v_lshl_add_u32 v14, v15, 4, v14
    v_lshlrev_b32 v222, 4, v14
    v_mov_b32 v240, 0
    v_mov_b32 v241, 0
    v_mov_b32 v242, 0
    v_lshlrev_b32 v12, 4, v0
    s_mov_b64 vcc, -1
    s_branch L_stats
L_h0:
    s_getpc_b64 s[82:83]
    v_and_b32 v13, 1, v1
    v_lshl_add_u32 v13, v13, 5, s77
    v_lshlrev_b32 v13, 7, v13
    global_load_dword v226, v13, s[82:83]
    v_lshrrev_b32 v2, 5, v1
    v_and_b32 v7, 31, v1
    v_lshlrev_b32 v7, 4, v7
    v_lshl_add_u32 v7, v2, 10, v7
    s_lshr_b32 s80, s2, 1
    s_and_b32 s80, s80, 3
    s_lshl_b32 s80, s80, 3
    s_lshr_b32 s88, s77, 2
    s_add_u32 s80, s80, s88
    s_lshl_b32 s91, s80, 6
    s_lshl_b32 s88, s3, 1
    s_add_u32 s91, s91, s88
    s_sub_u32 s91, s91, 16
    s_waitcnt lgkmcnt(0)
    s_mov_b32 s32, s8
    s_mov_b32 s33, s9
    s_mov_b32 s34, 0x200000
    s_mov_b32 s35, 0x20000
    s_mov_b32 s29, s91
    global_load_dword v225, v12, s[30:31] sc1
    s_and_b32 s78, s77, 3
    s_lshl_b32 s78, s78, 2
    s_add_u32 s78, s78, s3
    s_sub_u32 s78, s78, 4
    s_mul_i32 s78, s78, 32
    s_lshl_b32 s88, s80, 9
    s_add_u32 s78, s78, s88
    v_min_u32 v13, 31, v1
    v_add_lshl_u32 v13, v13, s78, 7
    buffer_load_dword v226, v13, s[32:35], 0 offen
    s_max_i32 s78, s29, 0
    s_lshl_b32 s78, s78, 10
    buffer_load_dwordx4 v[16:19], v7, s[32:35], s78 offen offset:0
    buffer_load_dwordx4 v[20:23], v7, s[32:35], s78 offen offset:512
    s_mov_b32 s36, s10
    s_mov_b32 s37, s11
    s_mov_b32 s38, 0x180000
    s_mov_b32 s39, 0x20000
    s_lshl_b32 s78, s2, 2
    s_add_u32 s78, s78, s3
    s_sub_u32 s78, s78, 4
    s_mul_i32 s78, s78, 1536
    v_min_u32 v13, 11, v1
    v_lshlrev_b32 v13, 7, v13
    buffer_load_dword v226, v13, s[36:39], s78 offen
    s_cmp_ge_u32 s2, 64
    s_cbranch_scc1 L_nb1
    s_barrier
L_nb1:
    s_mov_b32 s14, s80
    s_and_b32 s15, s2, 1
    s_lshl_b32 s15, s15, 2
    s_bfe_u32 s88, s2, 0x20003
    s_add_u32 s15, s15, s88
    s_and_b32 s76, s2, 7
    s_lshr_b32 s77, s2, 3
    s_lshr_b32 s78, s77, 4
    s_lshl_b32 s4, s76, 1
    s_add_u32 s4, s4, s78
    s_and_b32 s5, s77, 15
    s_lshr_b32 s73, s5, 3
    s_and_b32 s7, s5, 7
    s_lshl_b32 s6, s4, 1
    s_add_u32 s6, s6, s73
    s_and_b32 s74, s3, 3
    s_lshl_b32 s89, s4, 11
    s_add_u32 s89, s89, 4096
    s_mov_b32 s88, 8192
    s_mov_b32 s60, s30
    s_mov_b32 s61, s31
    s_mov_b32 s62, 0xc00000
    s_mov_b32 s63, 0x20000
    s_mov_b32 s36, s10
    s_mov_b32 s37, s11
    s_mov_b32 s38, 0x180000
    s_mov_b32 s39, 0x20000
    s_mov_b32 s40, s12
    s_mov_b32 s41, s13
    s_mov_b32 s42, 0x80000
    s_mov_b32 s43, 0x20000
    s_mov_b32 s44, s16
    s_mov_b32 s45, s17
    s_mov_b32 s46, 0x1c0000
    s_mov_b32 s47, 0x20000
    s_mov_b32 s48, s18
    s_mov_b32 s49, s19
    s_mov_b32 s50, 0x1c0000
    s_mov_b32 s51, 0x20000
    s_mov_b32 s52, s20
    s_mov_b32 s53, s21
    s_mov_b32 s54, 0x1c0000
    s_mov_b32 s55, 0x20000
    s_mov_b32 s64, s26
    s_mov_b32 s65, s27
    s_mov_b32 s66, 0x200000
    s_mov_b32 s67, 0x20000
    s_and_b32 s72, s14, 7
    s_lshl_b32 s72, s72, 1
    v_lshrrev_b32 v2, 5, v1
    s_lshl_b32 s76, s3, 1
    v_add_u32 v2, s76, v2
    s_lshl_b32 s76, s72, 2
    v_and_b32 v14, 31, v1
    v_subrev_u32 v14, s76, v14
    v_and_b32 v14, 63, v14
    v_and_b32 v15, 15, v14
    v_xor_b32 v15, v15, v2
    v_lshlrev_b32 v15, 4, v15
    v_lshl_add_u32 v10, v2, 8, v15
    v_lshrrev_b32 v15, 4, v14
    v_mul_u32_u24 v15, 20480, v15
    v_add3_u32 v10, v10, v15, s88
    v_xor_b32 v14, 32, v14
    v_and_b32 v15, 15, v14
    v_xor_b32 v15, v15, v2
    v_lshlrev_b32 v15, 4, v15
    v_lshl_add_u32 v229, v2, 8, v15
    v_lshrrev_b32 v15, 4, v14
    v_mul_u32_u24 v15, 20480, v15
    v_add3_u32 v229, v229, v15, s88
    v_and_b32 v11, 31, v1
    v_lshlrev_b32 v11, 5, v11
    v_lshlrev_b32 v8, 4, v1
    v_and_b32 v2, 1, v6
    v_lshlrev_b32 v2, 1, v2
    s_and_b32 s76, s3, 1
    s_lshl_b32 s76, s76, 2
    v_or_b32 v2, s76, v2
    v_xor_b32 v2, v2, v5
    v_mul_u32_u24 v9, 3072, v4
    v_lshl_add_u32 v9, v2, 4, v9
    s_mul_i32 s90, s74, 24576
    s_lshl_b32 s76, s15, 7
    s_add_u32 s90, s90, s76
    s_lshl_b32 s91, s74, 10
    s_add_u32 s91, s91, 90112
    s_mul_i32 s72, s72, 98304
    v_mov_b32 v222, 0
    v_lshlrev_b32 v2, 1, v6
    v_xor_b32 v2, v2, v5
    v_mul_u32_u24 v3, 6144, v4
    v_lshl_add_u32 v3, v2, 4, v3
    s_min_u32 s78, s2, 191
    s_lshr_b32 s79, s78, 2
    s_and_b32 s88, s78, 3
    s_lshl_b32 s76, s88, 7
    s_lshl_b32 s78, s74, 5
    s_add_u32 s76, s76, s78
    s_mul_i32 s76, s76, 6144
    s_lshl_b32 s78, s79, 7
    s_add_u32 s82, s76, s78
    v_and_b32 v13, 127, v0
    s_lshl_b32 s78, s88, 7
    v_add_lshl_u32 v224, v13, s78, 1
    s_lshl_b32 s83, s79, 8
    s_lshl_b32 s78, s74, 6
    s_add_u32 s83, s83, s78
    s_mul_i32 s78, s88, 12288
    s_add_u32 s83, s83, s78
    s_add_u32 s83, s83, 65536
    s_mov_b64 vcc, 0
L_stats:
    v_mov_b32 v15, 0x3f803f80
    s_waitcnt vmcnt(1)
    s_add_u32 s78, s29, 16
    s_lshl_b32 s78, s78, 10
    buffer_load_dwordx4 v[24:27], v7, s[32:35], s78 offen offset:0
    buffer_load_dwordx4 v[28:31], v7, s[32:35], s78 offen offset:512
    s_add_u32 s78, s29, 32
    s_lshl_b32 s78, s78, 10
    buffer_load_dwordx4 v[32:35], v7, s[32:35], s78 offen offset:0
    buffer_load_dwordx4 v[36:39], v7, s[32:35], s78 offen offset:512
    v_dot2_f32_bf16 v176, v16, v15, 0
    v_dot2_f32_bf16 v177, v16, v16, 0
    v_dot2_f32_bf16 v176, v17, v15, v176
    v_dot2_f32_bf16 v177, v17, v17, v177
    v_dot2_f32_bf16 v176, v18, v15, v176
    v_dot2_f32_bf16 v177, v18, v18, v177
    v_dot2_f32_bf16 v176, v19, v15, v176
    v_dot2_f32_bf16 v177, v19, v19, v177
    v_dot2_f32_bf16 v176, v20, v15, v176
    v_dot2_f32_bf16 v177, v20, v20, v177
    v_dot2_f32_bf16 v176, v21, v15, v176
    v_dot2_f32_bf16 v177, v21, v21, v177
    v_dot2_f32_bf16 v176, v22, v15, v176
    v_dot2_f32_bf16 v177, v22, v22, v177
    v_dot2_f32_bf16 v176, v23, v15, v176
    v_dot2_f32_bf16 v177, v23, v23, v177
    v_lshlrev_b32 v64, 16, v16
    v_and_b32 v65, 0xffff0000, v16
    v_lshlrev_b32 v66, 16, v17
    v_and_b32 v67, 0xffff0000, v17
    v_lshlrev_b32 v68, 16, v18
    v_and_b32 v69, 0xffff0000, v18
    v_lshlrev_b32 v70, 16, v19
    v_and_b32 v71, 0xffff0000, v19
    v_lshlrev_b32 v72, 16, v20
    v_and_b32 v73, 0xffff0000, v20
    v_lshlrev_b32 v74, 16, v21
    v_and_b32 v75, 0xffff0000, v21
    v_lshlrev_b32 v76, 16, v22
    v_and_b32 v77, 0xffff0000, v22
    v_lshlrev_b32 v78, 16, v23
    v_and_b32 v79, 0xffff0000, v23
    s_add_u32 s78, s29, 48
    s_lshl_b32 s78, s78, 10
    buffer_load_dwordx4 v[40:43], v7, s[32:35], s78 offen offset:0
    buffer_load_dwordx4 v[44:47], v7, s[32:35], s78 offen offset:512
    s_waitcnt vmcnt(4)
    v_dot2_f32_bf16 v178, v24, v15, 0
    v_dot2_f32_bf16 v179, v24, v24, 0
    v_dot2_f32_bf16 v178, v25, v15, v178
    v_dot2_f32_bf16 v179, v25, v25, v179
    v_dot2_f32_bf16 v178, v26, v15, v178
    v_dot2_f32_bf16 v179, v26, v26, v179
    v_dot2_f32_bf16 v178, v27, v15, v178
    v_dot2_f32_bf16 v179, v27, v27, v179
    v_dot2_f32_bf16 v178, v28, v15, v178
    v_dot2_f32_bf16 v179, v28, v28, v179
    v_dot2_f32_bf16 v178, v29, v15, v178
    v_dot2_f32_bf16 v179, v29, v29, v179
    v_dot2_f32_bf16 v178, v30, v15, v178
    v_dot2_f32_bf16 v179, v30, v30, v179
    v_dot2_f32_bf16 v178, v31, v15, v178
    v_dot2_f32_bf16 v179, v31, v31, v179
    v_lshlrev_b32 v80, 16, v24
    v_and_b32 v81, 0xffff0000, v24
    v_lshlrev_b32 v82, 16, v25
    v_and_b32 v83, 0xffff0000, v25
    v_lshlrev_b32 v84, 16, v26
    v_and_b32 v85, 0xffff0000, v26
    v_lshlrev_b32 v86, 16, v27
    v_and_b32 v87, 0xffff0000, v27
    v_lshlrev_b32 v88, 16, v28
    v_and_b32 v89, 0xffff0000, v28
    v_lshlrev_b32 v90, 16, v29
    v_and_b32 v91, 0xffff0000, v29
    v_lshlrev_b32 v92, 16, v30
    v_and_b32 v93, 0xffff0000, v30
    v_lshlrev_b32 v94, 16, v31
    v_and_b32 v95, 0xffff0000, v31
    s_add_u32 s78, s29, 64
    s_lshl_b32 s78, s78, 10
    buffer_load_dwordx4 v[48:51], v7, s[32:35], s78 offen offset:0
    buffer_load_dwordx4 v[52:55], v7, s[32:35], s78 offen offset:512
    s_cbranch_vccnz L_role_1
    s_add_u32 m0, s91, 0
    s_add_u32 s76, s90, s72
    buffer_load_dwordx4 v9, s[36:39], s76 offen lds
    s_add_u32 m0, s91, 4096
    s_add_u32 s76, s90, s72
    s_add_u32 s76, s76, 1024
    buffer_load_dwordx4 v9, s[36:39], s76 offen lds
    s_add_u32 m0, s91, 8192
    s_add_u32 s76, s90, s72
    s_add_u32 s76, s76, 2048
    buffer_load_dwordx4 v9, s[36:39], s76 offen lds
    s_add_u32 s72, s72, 98304
    s_cmp_ge_u32 s72, 1572864
    s_cselect_b32 s72, 0, s72
L_role_1:
    s_cbranch_vccnz L_role_2
    s_waitcnt vmcnt(7)
L_role_2:
    s_cbranch_vccz L_role_3
    s_waitcnt vmcnt(4)
L_role_3:
    v_dot2_f32_bf16 v180, v32, v15, 0
    v_dot2_f32_bf16 v181, v32, v32, 0
    v_dot2_f32_bf16 v180, v33, v15, v180
    v_dot2_f32_bf16 v181, v33, v33, v181
    v_dot2_f32_bf16 v180, v34, v15, v180
    v_dot2_f32_bf16 v181, v34, v34, v181
    v_dot2_f32_bf16 v180, v35, v15, v180
    v_dot2_f32_bf16 v181, v35, v35, v181
    v_dot2_f32_bf16 v180, v36, v15, v180
    v_dot2_f32_bf16 v181, v36, v36, v181
    v_dot2_f32_bf16 v180, v37, v15, v180
    v_dot2_f32_bf16 v181, v37, v37, v181
    v_dot2_f32_bf16 v180, v38, v15, v180
    v_dot2_f32_bf16 v181, v38, v38, v181
    v_dot2_f32_bf16 v180, v39, v15, v180
    v_dot2_f32_bf16 v181, v39, v39, v181
    v_lshlrev_b32 v96, 16, v32
    v_and_b32 v97, 0xffff0000, v32
    v_lshlrev_b32 v98, 16, v33
    v_and_b32 v99, 0xffff0000, v33
    v_lshlrev_b32 v100, 16, v34
    v_and_b32 v101, 0xffff0000, v34
    v_lshlrev_b32 v102, 16, v35
    v_and_b32 v103, 0xffff0000, v35
    v_lshlrev_b32 v104, 16, v36
    v_and_b32 v105, 0xffff0000, v36
    v_lshlrev_b32 v106, 16, v37
    v_and_b32 v107, 0xffff0000, v37
    v_lshlrev_b32 v108, 16, v38
    v_and_b32 v109, 0xffff0000, v38
    v_lshlrev_b32 v110, 16, v39
    v_and_b32 v111, 0xffff0000, v39
    s_cbranch_vccnz L_role_4
    s_add_u32 m0, s91, 12288
    s_add_u32 s76, s90, s72
    buffer_load_dwordx4 v9, s[36:39], s76 offen lds
    s_add_u32 m0, s91, 16384
    s_add_u32 s76, s90, s72
    s_add_u32 s76, s76, 1024
    buffer_load_dwordx4 v9, s[36:39], s76 offen lds
    s_add_u32 m0, s91, 20480
    s_add_u32 s76, s90, s72
    s_add_u32 s76, s76, 2048
    buffer_load_dwordx4 v9, s[36:39], s76 offen lds
    s_add_u32 s72, s72, 98304
    s_cmp_ge_u32 s72, 1572864
    s_cselect_b32 s72, 0, s72
L_role_4:
    s_cbranch_vccnz L_role_5
    s_waitcnt vmcnt(8)
L_role_5:
    s_cbranch_vccz L_role_6
    s_waitcnt vmcnt(2)
L_role_6:
    v_dot2_f32_bf16 v182, v40, v15, 0
    v_dot2_f32_bf16 v183, v40, v40, 0
    v_dot2_f32_bf16 v182, v41, v15, v182
    v_dot2_f32_bf16 v183, v41, v41, v183
    v_dot2_f32_bf16 v182, v42, v15, v182
    v_dot2_f32_bf16 v183, v42, v42, v183
    v_dot2_f32_bf16 v182, v43, v15, v182
    v_dot2_f32_bf16 v183, v43, v43, v183
    v_dot2_f32_bf16 v182, v44, v15, v182
    v_dot2_f32_bf16 v183, v44, v44, v183
    v_dot2_f32_bf16 v182, v45, v15, v182
    v_dot2_f32_bf16 v183, v45, v45, v183
    v_dot2_f32_bf16 v182, v46, v15, v182
    v_dot2_f32_bf16 v183, v46, v46, v183
    v_dot2_f32_bf16 v182, v47, v15, v182
    v_dot2_f32_bf16 v183, v47, v47, v183
    v_lshlrev_b32 v112, 16, v40
    v_and_b32 v113, 0xffff0000, v40
    v_lshlrev_b32 v114, 16, v41
    v_and_b32 v115, 0xffff0000, v41
    v_lshlrev_b32 v116, 16, v42
    v_and_b32 v117, 0xffff0000, v42
    v_lshlrev_b32 v118, 16, v43
    v_and_b32 v119, 0xffff0000, v43
    v_lshlrev_b32 v120, 16, v44
    v_and_b32 v121, 0xffff0000, v44
    v_lshlrev_b32 v122, 16, v45
    v_and_b32 v123, 0xffff0000, v45
    v_lshlrev_b32 v124, 16, v46
    v_and_b32 v125, 0xffff0000, v46
    v_lshlrev_b32 v126, 16, v47
    v_and_b32 v127, 0xffff0000, v47
    s_cbranch_vccnz L_role_7
    s_waitcnt vmcnt(6)
L_role_7:
    s_cbranch_vccz L_role_8
    s_waitcnt vmcnt(0)
L_role_8:
    v_dot2_f32_bf16 v184, v48, v15, 0
    v_dot2_f32_bf16 v185, v48, v48, 0
    v_dot2_f32_bf16 v184, v49, v15, v184
    v_dot2_f32_bf16 v185, v49, v49, v185
    v_dot2_f32_bf16 v184, v50, v15, v184
    v_dot2_f32_bf16 v185, v50, v50, v185
    v_dot2_f32_bf16 v184, v51, v15, v184
    v_dot2_f32_bf16 v185, v51, v51, v185
    v_dot2_f32_bf16 v184, v52, v15, v184
    v_dot2_f32_bf16 v185, v52, v52, v185
    v_dot2_f32_bf16 v184, v53, v15, v184
    v_dot2_f32_bf16 v185, v53, v53, v185
    v_dot2_f32_bf16 v184, v54, v15, v184
    v_dot2_f32_bf16 v185, v54, v54, v185
    v_dot2_f32_bf16 v184, v55, v15, v184
    v_dot2_f32_bf16 v185, v55, v55, v185
    s_nop 0
    v_permlane16_swap_b32 v176, v177
    v_permlane16_swap_b32 v178, v179
    v_permlane16_swap_b32 v180, v181
    v_permlane16_swap_b32 v182, v183
    v_permlane16_swap_b32 v184, v185
    v_add_f32 v176, v176, v177
    v_add_f32 v178, v178, v179
    v_add_f32 v180, v180, v181
    v_add_f32 v182, v182, v183
    v_add_f32 v184, v184, v185
    v_add_f32_dpp v176, v176, v176 quad_perm:[1,0,3,2] row_mask:0xf bank_mask:0xf
    v_add_f32_dpp v178, v178, v178 quad_perm:[1,0,3,2] row_mask:0xf bank_mask:0xf
    v_add_f32_dpp v180, v180, v180 quad_perm:[1,0,3,2] row_mask:0xf bank_mask:0xf
    v_add_f32_dpp v182, v182, v182 quad_perm:[1,0,3,2] row_mask:0xf bank_mask:0xf
    v_add_f32_dpp v184, v184, v184 quad_perm:[1,0,3,2] row_mask:0xf bank_mask:0xf
    v_add_f32_dpp v176, v176, v176 quad_perm:[2,3,0,1] row_mask:0xf bank_mask:0xf
    v_add_f32_dpp v178, v178, v178 quad_perm:[2,3,0,1] row_mask:0xf bank_mask:0xf
    v_add_f32_dpp v180, v180, v180 quad_perm:[2,3,0,1] row_mask:0xf bank_mask:0xf
    v_add_f32_dpp v182, v182, v182 quad_perm:[2,3,0,1] row_mask:0xf bank_mask:0xf
    v_add_f32_dpp v184, v184, v184 quad_perm:[2,3,0,1] row_mask:0xf bank_mask:0xf
    v_add_f32_dpp v176, v176, v176 row_half_mirror row_mask:0xf bank_mask:0xf
    v_add_f32_dpp v178, v178, v178 row_half_mirror row_mask:0xf bank_mask:0xf
    v_add_f32_dpp v180, v180, v180 row_half_mirror row_mask:0xf bank_mask:0xf
    v_add_f32_dpp v182, v182, v182 row_half_mirror row_mask:0xf bank_mask:0xf
    v_add_f32_dpp v184, v184, v184 row_half_mirror row_mask:0xf bank_mask:0xf
    v_add_f32_dpp v176, v176, v176 row_mirror row_mask:0xf bank_mask:0xf
    v_add_f32_dpp v178, v178, v178 row_mirror row_mask:0xf bank_mask:0xf
    v_add_f32_dpp v180, v180, v180 row_mirror row_mask:0xf bank_mask:0xf
    v_add_f32_dpp v182, v182, v182 row_mirror row_mask:0xf bank_mask:0xf
    v_add_f32_dpp v184, v184, v184 row_mirror row_mask:0xf bank_mask:0xf
    s_cbranch_vccnz L_role_9
    s_add_u32 m0, s91, 24576
    s_add_u32 s76, s90, s72
    buffer_load_dwordx4 v9, s[36:39], s76 offen lds
    s_add_u32 m0, s91, 28672
    s_add_u32 s76, s90, s72
    s_add_u32 s76, s76, 1024
    buffer_load_dwordx4 v9, s[36:39], s76 offen lds
    s_add_u32 m0, s91, 32768
    s_add_u32 s76, s90, s72
    s_add_u32 s76, s76, 2048
    buffer_load_dwordx4 v9, s[36:39], s76 offen lds
    s_add_u32 s72, s72, 98304
    s_cmp_ge_u32 s72, 1572864
    s_cselect_b32 s72, 0, s72
L_role_9:
    v_mov_b32 v177, v176
    v_mov_b32 v179, v178
    v_mov_b32 v181, v180
    v_mov_b32 v183, v182
    v_mov_b32 v185, v184
    v_permlane16_swap_b32 v176, v177
    v_permlane16_swap_b32 v178, v179
    v_permlane16_swap_b32 v180, v181
    v_permlane16_swap_b32 v182, v183
    v_permlane16_swap_b32 v184, v185
    s_mov_b32 s79, 0x3b000000
    v_mul_f32 v176, s79, v176
    v_mul_f32 v178, s79, v178
    v_mul_f32 v180, s79, v180
    v_mul_f32 v182, s79, v182
    v_mul_f32 v184, s79, v184
    v_mul_f32 v186, v176, v176
    v_mul_f32 v188, v178, v178
    v_mul_f32 v190, v180, v180
    v_mul_f32 v192, v182, v182
    v_mul_f32 v194, v184, v184
    v_fma_f32 v186, v177, s79, -v186
    v_fma_f32 v188, v179, s79, -v188
    v_fma_f32 v190, v181, s79, -v190
    v_fma_f32 v192, v183, s79, -v192
    v_fma_f32 v194, v185, s79, -v194
    v_max_f32 v186, 0, v186
    v_max_f32 v188, 0, v188
    v_max_f32 v190, 0, v190
    v_max_f32 v192, 0, v192
    v_max_f32 v194, 0, v194
    v_add_f32 v186, 0x3727c5ac, v186
    v_add_f32 v188, 0x3727c5ac, v188
    v_add_f32 v190, 0x3727c5ac, v190
    v_add_f32 v192, 0x3727c5ac, v192
    v_add_f32 v194, 0x3727c5ac, v194
    v_rsq_f32 v186, v186
    v_rsq_f32 v188, v188
    v_rsq_f32 v190, v190
    v_rsq_f32 v192, v192
    v_rsq_f32 v194, v194
    v_lshlrev_b32 v128, 16, v48
    v_and_b32 v129, 0xffff0000, v48
    v_lshlrev_b32 v130, 16, v49
    v_and_b32 v131, 0xffff0000, v49
    v_lshlrev_b32 v132, 16, v50
    v_and_b32 v133, 0xffff0000, v50
    v_lshlrev_b32 v134, 16, v51
    v_and_b32 v135, 0xffff0000, v51
    v_lshlrev_b32 v136, 16, v52
    v_and_b32 v137, 0xffff0000, v52
    v_lshlrev_b32 v138, 16, v53
    v_and_b32 v139, 0xffff0000, v53
    v_lshlrev_b32 v140, 16, v54
    v_and_b32 v141, 0xffff0000, v54
    v_lshlrev_b32 v142, 16, v55
    v_and_b32 v143, 0xffff0000, v55
    v_mul_f32_e64 v187, v176, -v186
    v_mul_f32_e64 v189, v178, -v188
    v_mul_f32_e64 v191, v180, -v190
    v_mul_f32_e64 v193, v182, -v192
    v_mul_f32_e64 v195, v184, -v194
    s_cbranch_vccnz L_role_10
    s_add_u32 m0, s91, 36864
    s_add_u32 s76, s90, s72
    buffer_load_dwordx4 v9, s[36:39], s76 offen lds
    s_add_u32 m0, s91, 40960
    s_add_u32 s76, s90, s72
    s_add_u32 s76, s76, 1024
    buffer_load_dwordx4 v9, s[36:39], s76 offen lds
    s_add_u32 m0, s91, 45056
    s_add_u32 s76, s90, s72
    s_add_u32 s76, s76, 2048
    buffer_load_dwordx4 v9, s[36:39], s76 offen lds
    s_add_u32 s72, s72, 98304
    s_cmp_ge_u32 s72, 1572864
    s_cselect_b32 s72, 0, s72
L_role_10:
    v_pk_fma_f32 v[64:65], v[64:65], v[186:187], v[186:187] op_sel:[0,0,1] op_sel_hi:[1,0,1]
    v_pk_fma_f32 v[66:67], v[66:67], v[186:187], v[186:187] op_sel:[0,0,1] op_sel_hi:[1,0,1]
    v_pk_fma_f32 v[68:69], v[68:69], v[186:187], v[186:187] op_sel:[0,0,1] op_sel_hi:[1,0,1]
    v_pk_fma_f32 v[70:71], v[70:71], v[186:187], v[186:187] op_sel:[0,0,1] op_sel_hi:[1,0,1]
    v_pk_fma_f32 v[72:73], v[72:73], v[186:187], v[186:187] op_sel:[0,0,1] op_sel_hi:[1,0,1]
    v_pk_fma_f32 v[74:75], v[74:75], v[186:187], v[186:187] op_sel:[0,0,1] op_sel_hi:[1,0,1]
    v_pk_fma_f32 v[76:77], v[76:77], v[186:187], v[186:187] op_sel:[0,0,1] op_sel_hi:[1,0,1]
    v_pk_fma_f32 v[78:79], v[78:79], v[186:187], v[186:187] op_sel:[0,0,1] op_sel_hi:[1,0,1]
    v_pk_fma_f32 v[80:81], v[80:81], v[188:189], v[188:189] op_sel:[0,0,1] op_sel_hi:[1,0,1]
    v_pk_fma_f32 v[82:83], v[82:83], v[188:189], v[188:189] op_sel:[0,0,1] op_sel_hi:[1,0,1]
    v_pk_fma_f32 v[84:85], v[84:85], v[188:189], v[188:189] op_sel:[0,0,1] op_sel_hi:[1,0,1]
    v_pk_fma_f32 v[86:87], v[86:87], v[188:189], v[188:189] op_sel:[0,0,1] op_sel_hi:[1,0,1]
    v_pk_fma_f32 v[88:89], v[88:89], v[188:189], v[188:189] op_sel:[0,0,1] op_sel_hi:[1,0,1]
    v_pk_fma_f32 v[90:91], v[90:91], v[188:189], v[188:189] op_sel:[0,0,1] op_sel_hi:[1,0,1]
    v_pk_fma_f32 v[92:93], v[92:93], v[188:189], v[188:189] op_sel:[0,0,1] op_sel_hi:[1,0,1]
    v_pk_fma_f32 v[94:95], v[94:95], v[188:189], v[188:189] op_sel:[0,0,1] op_sel_hi:[1,0,1]
    s_cbranch_vccz L_role_11
    s_mov_b32 s76, 65536
    buffer_load_dwordx4 v[236:239], v12, s[60:63], s76 offen sc1
    s_mov_b32 s76, 77824
    buffer_load_dwordx4 v[240:243], v12, s[60:63], s76 offen sc1
    s_mov_b32 s76, 90112
    buffer_load_dwordx4 v[244:247], v12, s[60:63], s76 offen sc1
    s_mov_b32 s76, 102400
    buffer_load_dwordx4 v[248:251], v12, s[60:63], s76 offen sc1
L_role_11:
    s_cbranch_vccnz L_role_12
    s_add_u32 m0, s91, 49152
    s_add_u32 s76, s90, s72
    buffer_load_dwordx4 v9, s[36:39], s76 offen lds
    s_add_u32 m0, s91, 53248
    s_add_u32 s76, s90, s72
    s_add_u32 s76, s76, 1024
    buffer_load_dwordx4 v9, s[36:39], s76 offen lds
    s_add_u32 m0, s91, 57344
    s_add_u32 s76, s90, s72
    s_add_u32 s76, s76, 2048
    buffer_load_dwordx4 v9, s[36:39], s76 offen lds
    s_add_u32 s72, s72, 98304
    s_cmp_ge_u32 s72, 1572864
    s_cselect_b32 s72, 0, s72
L_role_12:
    v_pk_fma_f32 v[96:97], v[96:97], v[190:191], v[190:191] op_sel:[0,0,1] op_sel_hi:[1,0,1]
    v_pk_fma_f32 v[98:99], v[98:99], v[190:191], v[190:191] op_sel:[0,0,1] op_sel_hi:[1,0,1]
    v_pk_fma_f32 v[100:101], v[100:101], v[190:191], v[190:191] op_sel:[0,0,1] op_sel_hi:[1,0,1]
    v_pk_fma_f32 v[102:103], v[102:103], v[190:191], v[190:191] op_sel:[0,0,1] op_sel_hi:[1,0,1]
    v_pk_fma_f32 v[104:105], v[104:105], v[190:191], v[190:191] op_sel:[0,0,1] op_sel_hi:[1,0,1]
    v_pk_fma_f32 v[106:107], v[106:107], v[190:191], v[190:191] op_sel:[0,0,1] op_sel_hi:[1,0,1]
    v_pk_fma_f32 v[108:109], v[108:109], v[190:191], v[190:191] op_sel:[0,0,1] op_sel_hi:[1,0,1]
    v_pk_fma_f32 v[110:111], v[110:111], v[190:191], v[190:191] op_sel:[0,0,1] op_sel_hi:[1,0,1]
    v_pk_fma_f32 v[112:113], v[112:113], v[192:193], v[192:193] op_sel:[0,0,1] op_sel_hi:[1,0,1]
    v_pk_fma_f32 v[114:115], v[114:115], v[192:193], v[192:193] op_sel:[0,0,1] op_sel_hi:[1,0,1]
    v_pk_fma_f32 v[116:117], v[116:117], v[192:193], v[192:193] op_sel:[0,0,1] op_sel_hi:[1,0,1]
    v_pk_fma_f32 v[118:119], v[118:119], v[192:193], v[192:193] op_sel:[0,0,1] op_sel_hi:[1,0,1]
    v_pk_fma_f32 v[120:121], v[120:121], v[192:193], v[192:193] op_sel:[0,0,1] op_sel_hi:[1,0,1]
    v_pk_fma_f32 v[122:123], v[122:123], v[192:193], v[192:193] op_sel:[0,0,1] op_sel_hi:[1,0,1]
    v_pk_fma_f32 v[124:125], v[124:125], v[192:193], v[192:193] op_sel:[0,0,1] op_sel_hi:[1,0,1]
    v_pk_fma_f32 v[126:127], v[126:127], v[192:193], v[192:193] op_sel:[0,0,1] op_sel_hi:[1,0,1]
    v_pk_fma_f32 v[128:129], v[128:129], v[194:195], v[194:195] op_sel:[0,0,1] op_sel_hi:[1,0,1]
    v_pk_fma_f32 v[130:131], v[130:131], v[194:195], v[194:195] op_sel:[0,0,1] op_sel_hi:[1,0,1]
    v_pk_fma_f32 v[132:133], v[132:133], v[194:195], v[194:195] op_sel:[0,0,1] op_sel_hi:[1,0,1]
    v_pk_fma_f32 v[134:135], v[134:135], v[194:195], v[194:195] op_sel:[0,0,1] op_sel_hi:[1,0,1]
    v_pk_fma_f32 v[136:137], v[136:137], v[194:195], v[194:195] op_sel:[0,0,1] op_sel_hi:[1,0,1]
    v_pk_fma_f32 v[138:139], v[138:139], v[194:195], v[194:195] op_sel:[0,0,1] op_sel_hi:[1,0,1]
    v_pk_fma_f32 v[140:141], v[140:141], v[194:195], v[194:195] op_sel:[0,0,1] op_sel_hi:[1,0,1]
    v_pk_fma_f32 v[142:143], v[142:143], v[194:195], v[194:195] op_sel:[0,0,1] op_sel_hi:[1,0,1]
    s_cmp_lt_u32 s3, 4
    s_cbranch_scc1 L_mgather
    s_add_u32 m0, s91, 61440
    s_add_u32 s76, s90, s72
    buffer_load_dwordx4 v9, s[36:39], s76 offen lds
    s_add_u32 m0, s91, 65536
    s_add_u32 s76, s90, s72
    s_add_u32 s76, s76, 1024
    buffer_load_dwordx4 v9, s[36:39], s76 offen lds
    s_add_u32 m0, s91, 69632
    s_add_u32 s76, s90, s72
    s_add_u32 s76, s76, 2048
    buffer_load_dwordx4 v9, s[36:39], s76 offen lds
    s_add_u32 s72, s72, 98304
    s_cmp_ge_u32 s72, 1572864
    s_cselect_b32 s72, 0, s72
    s_lshr_b32 s77, s2, 3
    s_lshl_b32 s78, s2, 7
    s_add_u32 s88, s78, 4096
    v_mov_b32 v13, s88
    s_min_u32 s88, s78, 2048
    s_add_u32 s88, s88, 36864
    v_mov_b32 v14, s88
    v_cmp_eq_u32 vcc, 1, v1
    s_add_u32 s88, s78, 393216
    s_nop 0
    v_cndmask_b32 v13, v13, v14, vcc
    v_mov_b32 v14, s88
    v_cmp_eq_u32 vcc, 2, v1
    s_nop 1
    v_cndmask_b32 v13, v13, v14, vcc
    global_load_dword v226, v13, s[30:31] sc1
    s_lshl_b32 s76, s2, 2
    s_add_u32 s76, s76, s74
    s_lshl_b32 s77, s76, 9
    s_mul_i32 s29, s76, 1792
    v_and_b32 v15, 3, v1
    v_lshlrev_b32 v15, 7, v15
    v_min_u32 v17, 13, v1
    v_lshlrev_b32 v17, 7, v17
    buffer_load_dword v226, v15, s[40:43], s77 offen
    buffer_load_dword v226, v17, s[44:47], s29 offen
    buffer_load_dword v226, v17, s[48:51], s29 offen
    buffer_load_dword v226, v17, s[52:55], s29 offen
    s_lshr_b32 s77, s2, 3
    s_getpc_b64 s[80:81]
L_pcbase:
    v_and_b32 v15, 15, v1
    v_lshl_add_u32 v15, v15, 5, s77
    v_lshlrev_b32 v15, 7, v15
    v_min_u32 v15, L_codeend-L_pcbase-4, v15
    global_load_dword v226, v15, s[80:81]
    s_mov_b32 s32, s24
    s_mov_b32 s33, s25
    s_mov_b32 s34, 0x300000
    s_mov_b32 s35, 0x20000
    v_and_b32 v15, 31, v1
    v_mul_u32_u24 v15, 6144, v15
    s_sub_u32 s76, s2, 64
    s_cmp_ge_u32 s76, 128
    s_cselect_b32 s76, 0x40000000, 0
    v_or_b32 v15, s76, v15
    buffer_load_dword v226, v15, s[32:35], s82 offen
    s_branch L_b2
L_mgather:
    v_readfirstlane_b32 s76, v225
    s_nop 0
    s_mul_i32 s77, s76, 0x9E3779B1
    s_lshr_b32 s78, s77, 15
    s_xor_b32 s77, s77, s78
    s_or_b32 s77, s77, 0x01010101
    s_xor_b32 s68, s76, s77
    s_waitcnt vmcnt(0)
    v_mov_b32 v234, 0x0c0c0400
    v_mov_b32 v235, 0x04000c0c
    s_mov_b32 s88, 0
    s_branch L_pm1_c
L_pm1:
    s_mov_b32 s76, 65536
    buffer_load_dwordx4 v[236:239], v12, s[60:63], s76 offen sc1
    s_mov_b32 s76, 77824
    buffer_load_dwordx4 v[240:243], v12, s[60:63], s76 offen sc1
    s_mov_b32 s76, 90112
    buffer_load_dwordx4 v[244:247], v12, s[60:63], s76 offen sc1
    s_mov_b32 s76, 102400
    buffer_load_dwordx4 v[248:251], v12, s[60:63], s76 offen sc1
    s_waitcnt vmcnt(0)
L_pm1_c:
    s_add_u32 s88, s88, 1
    s_cmp_gt_u32 s88, 0x40000
    s_cbranch_scc1 L_pm1_x
    v_perm_b32 v231, v237, v236, v234
    v_perm_b32 v232, v239, v238, v235
    v_or_b32 v230, v231, v232
    v_xor_b32 v230, s68, v230
    v_perm_b32 v231, v241, v240, v234
    v_perm_b32 v232, v243, v242, v235
    v_or_b32 v231, v231, v232
    v_xor_b32 v231, s68, v231
    v_or_b32 v230, v230, v231
    v_perm_b32 v231, v245, v244, v234
    v_perm_b32 v232, v247, v246, v235
    v_or_b32 v231, v231, v232
    v_xor_b32 v231, s68, v231
    v_or_b32 v230, v230, v231
    v_perm_b32 v231, v249, v248, v234
    v_perm_b32 v232, v251, v250, v235
    v_or_b32 v231, v231, v232
    v_xor_b32 v231, s68, v231
    v_or_b32 v230, v230, v231
    v_cmp_ne_u32 vcc, 0, v230
    s_cbranch_vccnz L_pm1
L_pm1_x:
    v_and_b32 v236, 0xffffff00, v236
    v_and_b32 v237, 0xffffff00, v237
    v_and_b32 v238, 0xffffff00, v238
    v_and_b32 v239, 0xffffff00, v239
    v_and_b32 v240, 0xffffff00, v240
    v_and_b32 v241, 0xffffff00, v241
    v_and_b32 v242, 0xffffff00, v242
    v_and_b32 v243, 0xffffff00, v243
    v_and_b32 v244, 0xffffff00, v244
    v_and_b32 v245, 0xffffff00, v245
    v_and_b32 v246, 0xffffff00, v246
    v_and_b32 v247, 0xffffff00, v247
    v_and_b32 v248, 0xffffff00, v248
    v_and_b32 v249, 0xffffff00, v249
    v_and_b32 v250, 0xffffff00, v250
    v_and_b32 v251, 0xffffff00, v251
    v_pk_add_f32 v[236:237], v[236:237], v[240:241]
    v_pk_add_f32 v[238:239], v[238:239], v[242:243]
    v_pk_add_f32 v[244:245], v[244:245], v[248:249]
    v_pk_add_f32 v[246:247], v[246:247], v[250:251]
    v_pk_add_f32 v[236:237], v[236:237], v[244:245]
    v_pk_add_f32 v[238:239], v[238:239], v[246:247]
    v_cvt_pk_bf16_f32 v230, v236, v237
    v_cvt_pk_bf16_f32 v231, v238, v239
    v_lshlrev_b32 v236, 16, v230
    v_and_b32 v237, 0xffff0000, v230
    v_lshlrev_b32 v238, 16, v231
    v_and_b32 v239, 0xffff0000, v231
    s_cmp_ge_u32 s3, 2
    s_cselect_b32 s76, 1.0, 0
    v_add_f32 v236, s76, v236
    v_add_f32 v237, s76, v237
    v_add_f32 v238, s76, v238
    v_add_f32 v239, s76, v239
    v_cvt_pk_bf16_f32 v230, v236, v237
    v_cvt_pk_bf16_f32 v231, v238, v239
    v_lshlrev_b32 v236, 16, v230
    v_and_b32 v237, 0xffff0000, v230
    v_lshlrev_b32 v238, 16, v231
    v_and_b32 v239, 0xffff0000, v231
    ds_write_b128 v12, v[236:239] offset:0
    s_lshr_b32 s77, s2, 3
    s_mul_i32 s78, s77, 37
    s_lshr_b32 s78, s78, 8
    s_mul_i32 s79, s78, 7
    s_sub_u32 s79, s77, s79
    s_lshl_b32 s76, s78, 2
    s_and_b32 s28, s76, 15
    s_and_b32 s76, s2, 6
    s_lshl_b32 s76, s76, 1
    s_add_u32 s56, s76, s78
    s_min_u32 s56, s56, 15
    s_and_b32 s78, s2, 1
    s_mul_i32 s78, s78, 7
    s_add_u32 s57, s78, s79
    s_add_u32 s76, s76, s79
    s_lshl_b32 s78, s78, 1
    s_add_u32 s78, s78, s76
    s_cmp_ge_u32 s76, 14
    s_cselect_b32 s78, 31, s78
    s_lshl_b32 s59, s57, 1
    s_cmp_ge_u32 s77, 28
    s_cselect_b32 s57, 14, s57
    s_cselect_b32 s88, s78, s59
    s_cselect_b32 s28, 0, s28
    s_lshl_b32 s58, s56, 11
    s_add_u32 s58, s58, 4096
    s_mov_b32 s75, s88
    s_waitcnt lgkmcnt(0)
L_b2:
    s_barrier
    ds_read_b128 v[144:147], v11 offset:2048
    ds_read_b128 v[160:163], v11 offset:0
    ds_read_b128 v[148:151], v11 offset:2064
    ds_read_b128 v[164:167], v11 offset:16
    ds_read_b128 v[152:155], v11 offset:3072
    ds_read_b128 v[168:171], v11 offset:1024
    ds_read_b128 v[156:159], v11 offset:3088
    ds_read_b128 v[172:175], v11 offset:1040
    s_waitcnt lgkmcnt(0)
    v_pk_fma_f32 v[64:65], v[64:65], v[144:145], v[160:161]
    v_pk_fma_f32 v[66:67], v[66:67], v[146:147], v[162:163]
    v_pk_fma_f32 v[68:69], v[68:69], v[148:149], v[164:165]
    v_pk_fma_f32 v[70:71], v[70:71], v[150:151], v[166:167]
    v_cvt_pk_bf16_f32 v16, v64, v65
    v_cvt_pk_bf16_f32 v17, v66, v67
    v_cvt_pk_bf16_f32 v18, v68, v69
    v_cvt_pk_bf16_f32 v19, v70, v71
    ds_write_b128 v10, v[16:19] offset:0
    v_pk_fma_f32 v[72:73], v[72:73], v[152:153], v[168:169]
    v_pk_fma_f32 v[74:75], v[74:75], v[154:155], v[170:171]
    v_pk_fma_f32 v[76:77], v[76:77], v[156:157], v[172:173]
    v_pk_fma_f32 v[78:79], v[78:79], v[158:159], v[174:175]
    v_cvt_pk_bf16_f32 v20, v72, v73
    v_cvt_pk_bf16_f32 v21, v74, v75
    v_cvt_pk_bf16_f32 v22, v76, v77
    v_cvt_pk_bf16_f32 v23, v78, v79
    ds_write_b128 v229, v[20:23] offset:0
    v_pk_fma_f32 v[80:81], v[80:81], v[144:145], v[160:161]
    v_pk_fma_f32 v[82:83], v[82:83], v[146:147], v[162:163]
    v_pk_fma_f32 v[84:85], v[84:85], v[148:149], v[164:165]
    v_pk_fma_f32 v[86:87], v[86:87], v[150:151], v[166:167]
    v_cvt_pk_bf16_f32 v24, v80, v81
    v_cvt_pk_bf16_f32 v25, v82, v83
    v_cvt_pk_bf16_f32 v26, v84, v85
    v_cvt_pk_bf16_f32 v27, v86, v87
    ds_write_b128 v10, v[24:27] offset:4096
    v_pk_fma_f32 v[88:89], v[88:89], v[152:153], v[168:169]
    v_pk_fma_f32 v[90:91], v[90:91], v[154:155], v[170:171]
    v_pk_fma_f32 v[92:93], v[92:93], v[156:157], v[172:173]
    v_pk_fma_f32 v[94:95], v[94:95], v[158:159], v[174:175]
    v_cvt_pk_bf16_f32 v28, v88, v89
    v_cvt_pk_bf16_f32 v29, v90, v91
    v_cvt_pk_bf16_f32 v30, v92, v93
    v_cvt_pk_bf16_f32 v31, v94, v95
    ds_write_b128 v229, v[28:31] offset:4096
    v_pk_fma_f32 v[96:97], v[96:97], v[144:145], v[160:161]
    v_pk_fma_f32 v[98:99], v[98:99], v[146:147], v[162:163]
    v_pk_fma_f32 v[100:101], v[100:101], v[148:149], v[164:165]
    v_pk_fma_f32 v[102:103], v[102:103], v[150:151], v[166:167]
    v_cvt_pk_bf16_f32 v32, v96, v97
    v_cvt_pk_bf16_f32 v33, v98, v99
    v_cvt_pk_bf16_f32 v34, v100, v101
    v_cvt_pk_bf16_f32 v35, v102, v103
    ds_write_b128 v10, v[32:35] offset:8192
    v_pk_fma_f32 v[104:105], v[104:105], v[152:153], v[168:169]
    v_pk_fma_f32 v[106:107], v[106:107], v[154:155], v[170:171]
    v_pk_fma_f32 v[108:109], v[108:109], v[156:157], v[172:173]
    v_pk_fma_f32 v[110:111], v[110:111], v[158:159], v[174:175]
    v_cvt_pk_bf16_f32 v36, v104, v105
    v_cvt_pk_bf16_f32 v37, v106, v107
    v_cvt_pk_bf16_f32 v38, v108, v109
    v_cvt_pk_bf16_f32 v39, v110, v111
    ds_write_b128 v229, v[36:39] offset:8192
    v_pk_fma_f32 v[112:113], v[112:113], v[144:145], v[160:161]
    v_pk_fma_f32 v[114:115], v[114:115], v[146:147], v[162:163]
    v_pk_fma_f32 v[116:117], v[116:117], v[148:149], v[164:165]
    v_pk_fma_f32 v[118:119], v[118:119], v[150:151], v[166:167]
    v_cvt_pk_bf16_f32 v40, v112, v113
    v_cvt_pk_bf16_f32 v41, v114, v115
    v_cvt_pk_bf16_f32 v42, v116, v117
    v_cvt_pk_bf16_f32 v43, v118, v119
    ds_write_b128 v10, v[40:43] offset:12288
    v_pk_fma_f32 v[120:121], v[120:121], v[152:153], v[168:169]
    v_pk_fma_f32 v[122:123], v[122:123], v[154:155], v[170:171]
    v_pk_fma_f32 v[124:125], v[124:125], v[156:157], v[172:173]
    v_pk_fma_f32 v[126:127], v[126:127], v[158:159], v[174:175]
    v_cvt_pk_bf16_f32 v44, v120, v121
    v_cvt_pk_bf16_f32 v45, v122, v123
    v_cvt_pk_bf16_f32 v46, v124, v125
    v_cvt_pk_bf16_f32 v47, v126, v127
    ds_write_b128 v229, v[44:47] offset:12288
    v_pk_fma_f32 v[128:129], v[128:129], v[144:145], v[160:161]
    v_pk_fma_f32 v[130:131], v[130:131], v[146:147], v[162:163]
    v_pk_fma_f32 v[132:133], v[132:133], v[148:149], v[164:165]
    v_pk_fma_f32 v[134:135], v[134:135], v[150:151], v[166:167]
    v_cvt_pk_bf16_f32 v48, v128, v129
    v_cvt_pk_bf16_f32 v49, v130, v131
    v_cvt_pk_bf16_f32 v50, v132, v133
    v_cvt_pk_bf16_f32 v51, v134, v135
    ds_write_b128 v10, v[48:51] offset:16384
    v_pk_fma_f32 v[136:137], v[136:137], v[152:153], v[168:169]
    v_pk_fma_f32 v[138:139], v[138:139], v[154:155], v[170:171]
    v_pk_fma_f32 v[140:141], v[140:141], v[156:157], v[172:173]
    v_pk_fma_f32 v[142:143], v[142:143], v[158:159], v[174:175]
    v_cvt_pk_bf16_f32 v52, v136, v137
    v_cvt_pk_bf16_f32 v53, v138, v139
    v_cvt_pk_bf16_f32 v54, v140, v141
    v_cvt_pk_bf16_f32 v55, v142, v143
    ds_write_b128 v229, v[52:55] offset:16384
    s_cmp_ge_u32 s3, 4
    s_cbranch_scc1 L_h
    s_waitcnt vmcnt(0) lgkmcnt(0)
    s_barrier
    s_setprio 1
    ds_read_b64_tr_b16 v[164:165], v208 offset:4096
    ds_read_b64_tr_b16 v[166:167], v208 offset:4608
    ds_read_b128 v[120:123], v200 offset:8192
    ds_read_b128 v[124:127], v200 offset:12288
    ds_read_b64_tr_b16 v[168:169], v208 offset:8192
    ds_read_b64_tr_b16 v[170:171], v208 offset:8704
    ds_read_b128 v[128:131], v200 offset:16384
    ds_read_b64_tr_b16 v[160:161], v208 offset:0
    ds_read_b64_tr_b16 v[162:163], v208 offset:512
    ds_read_b128 v[132:135], v200 offset:20480
    ds_read_b128 v[136:139], v200 offset:24576
    s_and_b32 s77, s3, 1
    s_lshr_b32 s79, s3, 1
    v_and_b32 v14, 31, v1
    v_lshrrev_b32 v15, 5, v1
    v_lshlrev_b32 v13, 4, v15
    v_lshl_add_u32 v11, v14, 10, v13
    s_lshl_b32 s76, s6, 1
    s_add_u32 s76, s76, s77
    s_lshl_b32 s78, s76, 15
    s_lshl_b32 s76, s7, 1
    s_add_u32 s76, s76, s79
    s_lshl_b32 s88, s76, 6
    s_add_u32 s88, s88, s78
    v_add_u32 v11, s88, v11
    s_waitcnt lgkmcnt(8)
    v_mfma_f32_16x16x32_bf16 v[80:83], v[164:167], v[120:123], 0
    s_barrier
    s_waitcnt lgkmcnt(7)
    v_mfma_f32_16x16x32_bf16 v[84:87], v[164:167], v[124:127], 0
    ds_read_b64_tr_b16 v[176:177], v208 offset:16384
    s_waitcnt lgkmcnt(6)
    v_mfma_f32_16x16x32_bf16 v[100:103], v[120:123], v[168:171], 0
    ds_read_b64_tr_b16 v[178:179], v208 offset:16896
    v_mfma_f32_16x16x32_bf16 v[104:107], v[124:127], v[168:171], 0
    ds_read_b128 v[140:143], v201 offset:8192
    s_waitcnt lgkmcnt(7)
    v_mfma_f32_16x16x32_bf16 v[88:91], v[164:167], v[128:131], 0
    ds_read_b128 v[144:147], v201 offset:12288
    v_mfma_f32_16x16x32_bf16 v[108:111], v[128:131], v[168:171], 0
    ds_read_b64_tr_b16 v[180:181], v208 offset:20480
    s_waitcnt lgkmcnt(7)
    v_mfma_f32_16x16x32_bf16 v[64:67], v[160:163], v[124:127], 0
    ds_read_b64_tr_b16 v[182:183], v208 offset:20992
    v_mfma_f32_16x16x32_bf16 v[68:71], v[160:163], v[128:131], 0
    ds_read_b128 v[148:151], v201 offset:16384
    s_waitcnt lgkmcnt(8)
    v_mfma_f32_16x16x32_bf16 v[92:95], v[164:167], v[132:135], 0
    ds_read_b64_tr_b16 v[172:173], v208 offset:12288
    v_mfma_f32_16x16x32_bf16 v[112:115], v[132:135], v[168:171], 0
    ds_read_b64_tr_b16 v[174:175], v208 offset:12800
    v_mfma_f32_16x16x32_bf16 v[72:75], v[160:163], v[132:135], 0
    ds_read_b128 v[152:155], v201 offset:20480
    s_waitcnt lgkmcnt(10)
    v_mfma_f32_16x16x32_bf16 v[96:99], v[164:167], v[136:139], 0
    ds_read_b128 v[156:159], v201 offset:24576
    v_mfma_f32_16x16x32_bf16 v[116:119], v[136:139], v[168:171], 0
    v_mfma_f32_16x16x32_bf16 v[76:79], v[160:163], v[136:139], 0
    s_waitcnt lgkmcnt(8)
    v_mfma_f32_16x16x32_bf16 v[80:83], v[176:179], v[140:143], v[80:83]
    s_barrier
    s_waitcnt lgkmcnt(7)
    v_mfma_f32_16x16x32_bf16 v[84:87], v[176:179], v[144:147], v[84:87]
    ds_read_b64_tr_b16 v[164:165], v208 offset:28672
    s_waitcnt lgkmcnt(6)
    v_mfma_f32_16x16x32_bf16 v[100:103], v[140:143], v[180:183], v[100:103]
    ds_read_b64_tr_b16 v[166:167], v208 offset:29184
    v_mfma_f32_16x16x32_bf16 v[104:107], v[144:147], v[180:183], v[104:107]
    ds_read_b128 v[120:123], v202 offset:8192
    s_waitcnt lgkmcnt(7)
    v_mfma_f32_16x16x32_bf16 v[88:91], v[176:179], v[148:151], v[88:91]
    ds_read_b128 v[124:127], v202 offset:12288
    v_mfma_f32_16x16x32_bf16 v[108:111], v[148:151], v[180:183], v[108:111]
    ds_read_b64_tr_b16 v[168:169], v208 offset:32768
    s_waitcnt lgkmcnt(7)
    v_mfma_f32_16x16x32_bf16 v[64:67], v[172:175], v[144:147], v[64:67]
    ds_read_b64_tr_b16 v[170:171], v208 offset:33280
    v_mfma_f32_16x16x32_bf16 v[68:71], v[172:175], v[148:151], v[68:71]
    ds_read_b128 v[128:131], v202 offset:16384
    s_waitcnt lgkmcnt(8)
    v_mfma_f32_16x16x32_bf16 v[92:95], v[176:179], v[152:155], v[92:95]
    ds_read_b64_tr_b16 v[160:161], v208 offset:24576
    v_mfma_f32_16x16x32_bf16 v[112:115], v[152:155], v[180:183], v[112:115]
    ds_read_b64_tr_b16 v[162:163], v208 offset:25088
    v_mfma_f32_16x16x32_bf16 v[72:75], v[172:175], v[152:155], v[72:75]
    ds_read_b128 v[132:135], v202 offset:20480
    s_waitcnt lgkmcnt(10)
    v_mfma_f32_16x16x32_bf16 v[96:99], v[176:179], v[156:159], v[96:99]
    ds_read_b128 v[136:139], v202 offset:24576
    v_mfma_f32_16x16x32_bf16 v[116:119], v[156:159], v[180:183], v[116:119]
    v_mfma_f32_16x16x32_bf16 v[76:79], v[172:175], v[156:159], v[76:79]
    s_waitcnt lgkmcnt(8)
    v_mfma_f32_16x16x32_bf16 v[80:83], v[164:167], v[120:123], v[80:83]
    s_barrier
    s_waitcnt lgkmcnt(7)
    v_mfma_f32_16x16x32_bf16 v[84:87], v[164:167], v[124:127], v[84:87]
    ds_read_b64_tr_b16 v[176:177], v209 offset:4096
    s_waitcnt lgkmcnt(6)
    v_mfma_f32_16x16x32_bf16 v[100:103], v[120:123], v[168:171], v[100:103]
    ds_read_b64_tr_b16 v[178:179], v209 offset:4608
    v_mfma_f32_16x16x32_bf16 v[104:107], v[124:127], v[168:171], v[104:107]
    ds_read_b128 v[140:143], v203 offset:8192
    s_waitcnt lgkmcnt(7)
    v_mfma_f32_16x16x32_bf16 v[88:91], v[164:167], v[128:131], v[88:91]
    ds_read_b128 v[144:147], v203 offset:12288
    v_mfma_f32_16x16x32_bf16 v[108:111], v[128:131], v[168:171], v[108:111]
    ds_read_b64_tr_b16 v[180:181], v209 offset:8192
    s_waitcnt lgkmcnt(7)
    v_mfma_f32_16x16x32_bf16 v[64:67], v[160:163], v[124:127], v[64:67]
    ds_read_b64_tr_b16 v[182:183], v209 offset:8704
    v_mfma_f32_16x16x32_bf16 v[68:71], v[160:163], v[128:131], v[68:71]
    ds_read_b128 v[148:151], v203 offset:16384
    s_waitcnt lgkmcnt(8)
    v_mfma_f32_16x16x32_bf16 v[92:95], v[164:167], v[132:135], v[92:95]
    ds_read_b64_tr_b16 v[172:173], v209 offset:0
    v_mfma_f32_16x16x32_bf16 v[112:115], v[132:135], v[168:171], v[112:115]
    ds_read_b64_tr_b16 v[174:175], v209 offset:512
    v_mfma_f32_16x16x32_bf16 v[72:75], v[160:163], v[132:135], v[72:75]
    ds_read_b128 v[152:155], v203 offset:20480
    s_waitcnt lgkmcnt(10)
    v_mfma_f32_16x16x32_bf16 v[96:99], v[164:167], v[136:139], v[96:99]
    ds_read_b128 v[156:159], v203 offset:24576
    v_mfma_f32_16x16x32_bf16 v[116:119], v[136:139], v[168:171], v[116:119]
    v_mfma_f32_16x16x32_bf16 v[76:79], v[160:163], v[136:139], v[76:79]
    s_waitcnt lgkmcnt(8)
    v_mfma_f32_16x16x32_bf16 v[80:83], v[176:179], v[140:143], v[80:83]
    s_barrier
    s_waitcnt lgkmcnt(7)
    v_mfma_f32_16x16x32_bf16 v[84:87], v[176:179], v[144:147], v[84:87]
    ds_read_b64_tr_b16 v[164:165], v209 offset:16384
    s_waitcnt lgkmcnt(6)
    v_mfma_f32_16x16x32_bf16 v[100:103], v[140:143], v[180:183], v[100:103]
    ds_read_b64_tr_b16 v[166:167], v209 offset:16896
    v_mfma_f32_16x16x32_bf16 v[104:107], v[144:147], v[180:183], v[104:107]
    ds_read_b128 v[120:123], v200 offset:28672
    s_waitcnt lgkmcnt(7)
    v_mfma_f32_16x16x32_bf16 v[88:91], v[176:179], v[148:151], v[88:91]
    ds_read_b128 v[124:127], v200 offset:32768
    v_mfma_f32_16x16x32_bf16 v[108:111], v[148:151], v[180:183], v[108:111]
    ds_read_b64_tr_b16 v[168:169], v209 offset:20480
    s_waitcnt lgkmcnt(7)
    v_mfma_f32_16x16x32_bf16 v[64:67], v[172:175], v[144:147], v[64:67]
    ds_read_b64_tr_b16 v[170:171], v209 offset:20992
    v_mfma_f32_16x16x32_bf16 v[68:71], v[172:175], v[148:151], v[68:71]
    ds_read_b128 v[128:131], v200 offset:36864
    s_waitcnt lgkmcnt(8)
    v_mfma_f32_16x16x32_bf16 v[92:95], v[176:179], v[152:155], v[92:95]
    ds_read_b64_tr_b16 v[160:161], v209 offset:12288
    v_mfma_f32_16x16x32_bf16 v[112:115], v[152:155], v[180:183], v[112:115]
    ds_read_b64_tr_b16 v[162:163], v209 offset:12800
    v_mfma_f32_16x16x32_bf16 v[72:75], v[172:175], v[152:155], v[72:75]
    ds_read_b128 v[132:135], v200 offset:40960
    s_waitcnt lgkmcnt(10)
    v_mfma_f32_16x16x32_bf16 v[96:99], v[176:179], v[156:159], v[96:99]
    ds_read_b128 v[136:139], v200 offset:45056
    v_mfma_f32_16x16x32_bf16 v[116:119], v[156:159], v[180:183], v[116:119]
    v_mfma_f32_16x16x32_bf16 v[76:79], v[172:175], v[156:159], v[76:79]
    s_waitcnt lgkmcnt(8)
    v_mfma_f32_16x16x32_bf16 v[80:83], v[164:167], v[120:123], v[80:83]
    s_barrier
    s_waitcnt lgkmcnt(7)
    v_mfma_f32_16x16x32_bf16 v[84:87], v[164:167], v[124:127], v[84:87]
    ds_read_b64_tr_b16 v[176:177], v209 offset:28672
    s_waitcnt lgkmcnt(6)
    v_mfma_f32_16x16x32_bf16 v[100:103], v[120:123], v[168:171], v[100:103]
    ds_read_b64_tr_b16 v[178:179], v209 offset:29184
    v_mfma_f32_16x16x32_bf16 v[104:107], v[124:127], v[168:171], v[104:107]
    ds_read_b128 v[140:143], v201 offset:28672
    s_waitcnt lgkmcnt(7)
    v_mfma_f32_16x16x32_bf16 v[88:91], v[164:167], v[128:131], v[88:91]
    ds_read_b128 v[144:147], v201 offset:32768
    v_mfma_f32_16x16x32_bf16 v[108:111], v[128:131], v[168:171], v[108:111]
    ds_read_b64_tr_b16 v[180:181], v209 offset:32768
    s_waitcnt lgkmcnt(7)
    v_mfma_f32_16x16x32_bf16 v[64:67], v[160:163], v[124:127], v[64:67]
    ds_read_b64_tr_b16 v[182:183], v209 offset:33280
    v_mfma_f32_16x16x32_bf16 v[68:71], v[160:163], v[128:131], v[68:71]
    ds_read_b128 v[148:151], v201 offset:36864
    s_waitcnt lgkmcnt(8)
    v_mfma_f32_16x16x32_bf16 v[92:95], v[164:167], v[132:135], v[92:95]
    ds_read_b64_tr_b16 v[172:173], v209 offset:24576
    v_mfma_f32_16x16x32_bf16 v[112:115], v[132:135], v[168:171], v[112:115]
    ds_read_b64_tr_b16 v[174:175], v209 offset:25088
    v_mfma_f32_16x16x32_bf16 v[72:75], v[160:163], v[132:135], v[72:75]
    ds_read_b128 v[152:155], v201 offset:40960
    s_waitcnt lgkmcnt(10)
    v_mfma_f32_16x16x32_bf16 v[96:99], v[164:167], v[136:139], v[96:99]
    ds_read_b128 v[156:159], v201 offset:45056
    v_mfma_f32_16x16x32_bf16 v[116:119], v[136:139], v[168:171], v[116:119]
    v_mfma_f32_16x16x32_bf16 v[76:79], v[160:163], v[136:139], v[76:79]
    s_waitcnt lgkmcnt(8)
    v_mfma_f32_16x16x32_bf16 v[80:83], v[176:179], v[140:143], v[80:83]
    s_barrier
    s_waitcnt lgkmcnt(7)
    v_mfma_f32_16x16x32_bf16 v[84:87], v[176:179], v[144:147], v[84:87]
    ds_read_b64_tr_b16 v[164:165], v208 offset:4096
    s_waitcnt lgkmcnt(6)
    v_mfma_f32_16x16x32_bf16 v[100:103], v[140:143], v[180:183], v[100:103]
    ds_read_b64_tr_b16 v[166:167], v208 offset:4608
    v_mfma_f32_16x16x32_bf16 v[104:107], v[144:147], v[180:183], v[104:107]
    ds_read_b128 v[120:123], v202 offset:28672
    s_waitcnt lgkmcnt(7)
    v_mfma_f32_16x16x32_bf16 v[88:91], v[176:179], v[148:151], v[88:91]
    ds_read_b128 v[124:127], v202 offset:32768
    v_mfma_f32_16x16x32_bf16 v[108:111], v[148:151], v[180:183], v[108:111]
    ds_read_b64_tr_b16 v[168:169], v208 offset:8192
    s_waitcnt lgkmcnt(7)
    v_mfma_f32_16x16x32_bf16 v[64:67], v[172:175], v[144:147], v[64:67]
    ds_read_b64_tr_b16 v[170:171], v208 offset:8704
    v_mfma_f32_16x16x32_bf16 v[68:71], v[172:175], v[148:151], v[68:71]
    ds_read_b128 v[128:131], v202 offset:36864
    s_waitcnt lgkmcnt(8)
    v_mfma_f32_16x16x32_bf16 v[92:95], v[176:179], v[152:155], v[92:95]
    ds_read_b64_tr_b16 v[160:161], v208 offset:0
    v_mfma_f32_16x16x32_bf16 v[112:115], v[152:155], v[180:183], v[112:115]
    ds_read_b64_tr_b16 v[162:163], v208 offset:512
    v_mfma_f32_16x16x32_bf16 v[72:75], v[172:175], v[152:155], v[72:75]
    ds_read_b128 v[132:135], v202 offset:40960
    s_waitcnt lgkmcnt(10)
    v_mfma_f32_16x16x32_bf16 v[96:99], v[176:179], v[156:159], v[96:99]
    ds_read_b128 v[136:139], v202 offset:45056
    v_mfma_f32_16x16x32_bf16 v[116:119], v[156:159], v[180:183], v[116:119]
    v_mfma_f32_16x16x32_bf16 v[76:79], v[172:175], v[156:159], v[76:79]
    s_waitcnt lgkmcnt(8)
    v_mfma_f32_16x16x32_bf16 v[80:83], v[164:167], v[120:123], v[80:83]
    s_barrier
    s_waitcnt lgkmcnt(7)
    v_mfma_f32_16x16x32_bf16 v[84:87], v[164:167], v[124:127], v[84:87]
    ds_read_b64_tr_b16 v[176:177], v208 offset:16384
    s_waitcnt lgkmcnt(6)
    v_mfma_f32_16x16x32_bf16 v[100:103], v[120:123], v[168:171], v[100:103]
    ds_read_b64_tr_b16 v[178:179], v208 offset:16896
    v_mfma_f32_16x16x32_bf16 v[104:107], v[124:127], v[168:171], v[104:107]
    ds_read_b128 v[140:143], v203 offset:28672
    s_waitcnt lgkmcnt(7)
    v_mfma_f32_16x16x32_bf16 v[88:91], v[164:167], v[128:131], v[88:91]
    ds_read_b128 v[144:147], v203 offset:32768
    v_mfma_f32_16x16x32_bf16 v[108:111], v[128:131], v[168:171], v[108:111]
    ds_read_b64_tr_b16 v[180:181], v208 offset:20480
    s_waitcnt lgkmcnt(7)
    v_mfma_f32_16x16x32_bf16 v[64:67], v[160:163], v[124:127], v[64:67]
    ds_read_b64_tr_b16 v[182:183], v208 offset:20992
    v_mfma_f32_16x16x32_bf16 v[68:71], v[160:163], v[128:131], v[68:71]
    ds_read_b128 v[148:151], v203 offset:36864
    s_waitcnt lgkmcnt(8)
    v_mfma_f32_16x16x32_bf16 v[92:95], v[164:167], v[132:135], v[92:95]
    ds_read_b64_tr_b16 v[172:173], v208 offset:12288
    v_mfma_f32_16x16x32_bf16 v[112:115], v[132:135], v[168:171], v[112:115]
    ds_read_b64_tr_b16 v[174:175], v208 offset:12800
    v_mfma_f32_16x16x32_bf16 v[72:75], v[160:163], v[132:135], v[72:75]
    ds_read_b128 v[152:155], v203 offset:40960
    s_waitcnt lgkmcnt(10)
    v_mfma_f32_16x16x32_bf16 v[96:99], v[164:167], v[136:139], v[96:99]
    ds_read_b128 v[156:159], v203 offset:45056
    v_mfma_f32_16x16x32_bf16 v[116:119], v[136:139], v[168:171], v[116:119]
    v_mfma_f32_16x16x32_bf16 v[76:79], v[160:163], v[136:139], v[76:79]
    s_waitcnt lgkmcnt(8)
    v_mfma_f32_16x16x32_bf16 v[80:83], v[176:179], v[140:143], v[80:83]
    s_barrier
    s_waitcnt lgkmcnt(7)
    v_mfma_f32_16x16x32_bf16 v[84:87], v[176:179], v[144:147], v[84:87]
    ds_read_b64_tr_b16 v[164:165], v208 offset:28672
    s_waitcnt lgkmcnt(6)
    v_mfma_f32_16x16x32_bf16 v[100:103], v[140:143], v[180:183], v[100:103]
    ds_read_b64_tr_b16 v[166:167], v208 offset:29184
    v_mfma_f32_16x16x32_bf16 v[104:107], v[144:147], v[180:183], v[104:107]
    ds_read_b128 v[120:123], v204 offset:8192
    s_waitcnt lgkmcnt(7)
    v_mfma_f32_16x16x32_bf16 v[88:91], v[176:179], v[148:151], v[88:91]
    ds_read_b128 v[124:127], v204 offset:12288
    v_mfma_f32_16x16x32_bf16 v[108:111], v[148:151], v[180:183], v[108:111]
    ds_read_b64_tr_b16 v[168:169], v208 offset:32768
    s_waitcnt lgkmcnt(7)
    v_mfma_f32_16x16x32_bf16 v[64:67], v[172:175], v[144:147], v[64:67]
    ds_read_b64_tr_b16 v[170:171], v208 offset:33280
    v_mfma_f32_16x16x32_bf16 v[68:71], v[172:175], v[148:151], v[68:71]
    ds_read_b128 v[128:131], v204 offset:16384
    s_waitcnt lgkmcnt(8)
    v_mfma_f32_16x16x32_bf16 v[92:95], v[176:179], v[152:155], v[92:95]
    ds_read_b64_tr_b16 v[160:161], v208 offset:24576
    v_mfma_f32_16x16x32_bf16 v[112:115], v[152:155], v[180:183], v[112:115]
    ds_read_b64_tr_b16 v[162:163], v208 offset:25088
    v_mfma_f32_16x16x32_bf16 v[72:75], v[172:175], v[152:155], v[72:75]
    ds_read_b128 v[132:135], v204 offset:20480
    s_waitcnt lgkmcnt(10)
    v_mfma_f32_16x16x32_bf16 v[96:99], v[176:179], v[156:159], v[96:99]
    ds_read_b128 v[136:139], v204 offset:24576
    v_mfma_f32_16x16x32_bf16 v[116:119], v[156:159], v[180:183], v[116:119]
    v_mfma_f32_16x16x32_bf16 v[76:79], v[172:175], v[156:159], v[76:79]
    s_waitcnt lgkmcnt(8)
    v_mfma_f32_16x16x32_bf16 v[80:83], v[164:167], v[120:123], v[80:83]
    s_barrier
    s_waitcnt lgkmcnt(7)
    v_mfma_f32_16x16x32_bf16 v[84:87], v[164:167], v[124:127], v[84:87]
    ds_read_b64_tr_b16 v[176:177], v209 offset:4096
    s_waitcnt lgkmcnt(6)
    v_mfma_f32_16x16x32_bf16 v[100:103], v[120:123], v[168:171], v[100:103]
    ds_read_b64_tr_b16 v[178:179], v209 offset:4608
    v_mfma_f32_16x16x32_bf16 v[104:107], v[124:127], v[168:171], v[104:107]
    ds_read_b128 v[140:143], v205 offset:8192
    s_waitcnt lgkmcnt(7)
    v_mfma_f32_16x16x32_bf16 v[88:91], v[164:167], v[128:131], v[88:91]
    ds_read_b128 v[144:147], v205 offset:12288
    v_mfma_f32_16x16x32_bf16 v[108:111], v[128:131], v[168:171], v[108:111]
    ds_read_b64_tr_b16 v[180:181], v209 offset:8192
    s_waitcnt lgkmcnt(7)
    v_mfma_f32_16x16x32_bf16 v[64:67], v[160:163], v[124:127], v[64:67]
    ds_read_b64_tr_b16 v[182:183], v209 offset:8704
    v_mfma_f32_16x16x32_bf16 v[68:71], v[160:163], v[128:131], v[68:71]
    ds_read_b128 v[148:151], v205 offset:16384
    s_waitcnt lgkmcnt(8)
    v_mfma_f32_16x16x32_bf16 v[92:95], v[164:167], v[132:135], v[92:95]
    ds_read_b64_tr_b16 v[172:173], v209 offset:0
    v_mfma_f32_16x16x32_bf16 v[112:115], v[132:135], v[168:171], v[112:115]
    ds_read_b64_tr_b16 v[174:175], v209 offset:512
    v_mfma_f32_16x16x32_bf16 v[72:75], v[160:163], v[132:135], v[72:75]
    ds_read_b128 v[152:155], v205 offset:20480
    s_waitcnt lgkmcnt(10)
    v_mfma_f32_16x16x32_bf16 v[96:99], v[164:167], v[136:139], v[96:99]
    ds_read_b128 v[156:159], v205 offset:24576
    v_mfma_f32_16x16x32_bf16 v[116:119], v[136:139], v[168:171], v[116:119]
    v_mfma_f32_16x16x32_bf16 v[76:79], v[160:163], v[136:139], v[76:79]
    s_waitcnt lgkmcnt(8)
    v_mfma_f32_16x16x32_bf16 v[80:83], v[176:179], v[140:143], v[80:83]
    s_barrier
    s_waitcnt lgkmcnt(7)
    v_mfma_f32_16x16x32_bf16 v[84:87], v[176:179], v[144:147], v[84:87]
    ds_read_b64_tr_b16 v[164:165], v209 offset:16384
    s_waitcnt lgkmcnt(6)
    v_mfma_f32_16x16x32_bf16 v[100:103], v[140:143], v[180:183], v[100:103]
    ds_read_b64_tr_b16 v[166:167], v209 offset:16896
    v_mfma_f32_16x16x32_bf16 v[104:107], v[144:147], v[180:183], v[104:107]
    ds_read_b128 v[120:123], v206 offset:8192
    s_waitcnt lgkmcnt(7)
    v_mfma_f32_16x16x32_bf16 v[88:91], v[176:179], v[148:151], v[88:91]
    ds_read_b128 v[124:127], v206 offset:12288
    v_mfma_f32_16x16x32_bf16 v[108:111], v[148:151], v[180:183], v[108:111]
    ds_read_b64_tr_b16 v[168:169], v209 offset:20480
    s_waitcnt lgkmcnt(7)
    v_mfma_f32_16x16x32_bf16 v[64:67], v[172:175], v[144:147], v[64:67]
    ds_read_b64_tr_b16 v[170:171], v209 offset:20992
    v_mfma_f32_16x16x32_bf16 v[68:71], v[172:175], v[148:151], v[68:71]
    ds_read_b128 v[128:131], v206 offset:16384
    s_waitcnt lgkmcnt(8)
    v_mfma_f32_16x16x32_bf16 v[92:95], v[176:179], v[152:155], v[92:95]
    ds_read_b64_tr_b16 v[160:161], v209 offset:12288
    v_mfma_f32_16x16x32_bf16 v[112:115], v[152:155], v[180:183], v[112:115]
    ds_read_b64_tr_b16 v[162:163], v209 offset:12800
    v_mfma_f32_16x16x32_bf16 v[72:75], v[172:175], v[152:155], v[72:75]
    ds_read_b128 v[132:135], v206 offset:20480
    s_waitcnt lgkmcnt(10)
    v_mfma_f32_16x16x32_bf16 v[96:99], v[176:179], v[156:159], v[96:99]
    ds_read_b128 v[136:139], v206 offset:24576
    v_mfma_f32_16x16x32_bf16 v[116:119], v[156:159], v[180:183], v[116:119]
    buffer_load_dwordx4 v[24:27], v11, s[32:35], 0 offen
    buffer_load_dwordx4 v[28:31], v11, s[32:35], 0 offen offset:32
    v_mfma_f32_16x16x32_bf16 v[76:79], v[172:175], v[156:159], v[76:79]
    s_waitcnt lgkmcnt(8)
    v_mfma_f32_16x16x32_bf16 v[80:83], v[164:167], v[120:123], v[80:83]
    s_barrier
    s_waitcnt lgkmcnt(7)
    v_mfma_f32_16x16x32_bf16 v[84:87], v[164:167], v[124:127], v[84:87]
    ds_read_b64_tr_b16 v[176:177], v209 offset:28672
    s_waitcnt lgkmcnt(6)
    v_mfma_f32_16x16x32_bf16 v[100:103], v[120:123], v[168:171], v[100:103]
    ds_read_b64_tr_b16 v[178:179], v209 offset:29184
    v_mfma_f32_16x16x32_bf16 v[104:107], v[124:127], v[168:171], v[104:107]
    ds_read_b128 v[140:143], v207 offset:8192
    s_waitcnt lgkmcnt(7)
    v_mfma_f32_16x16x32_bf16 v[88:91], v[164:167], v[128:131], v[88:91]
    ds_read_b128 v[144:147], v207 offset:12288
    v_mfma_f32_16x16x32_bf16 v[108:111], v[128:131], v[168:171], v[108:111]
    ds_read_b64_tr_b16 v[180:181], v209 offset:32768
    s_waitcnt lgkmcnt(7)
    v_mfma_f32_16x16x32_bf16 v[64:67], v[160:163], v[124:127], v[64:67]
    ds_read_b64_tr_b16 v[182:183], v209 offset:33280
    v_mfma_f32_16x16x32_bf16 v[68:71], v[160:163], v[128:131], v[68:71]
    ds_read_b128 v[148:151], v207 offset:16384
    s_waitcnt lgkmcnt(8)
    v_mfma_f32_16x16x32_bf16 v[92:95], v[164:167], v[132:135], v[92:95]
    ds_read_b64_tr_b16 v[172:173], v209 offset:24576
    v_mfma_f32_16x16x32_bf16 v[112:115], v[132:135], v[168:171], v[112:115]
    ds_read_b64_tr_b16 v[174:175], v209 offset:25088
    v_mfma_f32_16x16x32_bf16 v[72:75], v[160:163], v[132:135], v[72:75]
    ds_read_b128 v[152:155], v207 offset:20480
    s_waitcnt lgkmcnt(10)
    v_mfma_f32_16x16x32_bf16 v[96:99], v[164:167], v[136:139], v[96:99]
    ds_read_b128 v[156:159], v207 offset:24576
    v_mfma_f32_16x16x32_bf16 v[116:119], v[136:139], v[168:171], v[116:119]
    v_mfma_f32_16x16x32_bf16 v[76:79], v[160:163], v[136:139], v[76:79]
    s_waitcnt lgkmcnt(8)
    v_mfma_f32_16x16x32_bf16 v[80:83], v[176:179], v[140:143], v[80:83]
    s_barrier
    s_waitcnt lgkmcnt(7)
    v_mfma_f32_16x16x32_bf16 v[84:87], v[176:179], v[144:147], v[84:87]
    ds_read_b64_tr_b16 v[164:165], v208 offset:4096
    s_waitcnt lgkmcnt(6)
    v_mfma_f32_16x16x32_bf16 v[100:103], v[140:143], v[180:183], v[100:103]
    ds_read_b64_tr_b16 v[166:167], v208 offset:4608
    v_mfma_f32_16x16x32_bf16 v[104:107], v[144:147], v[180:183], v[104:107]
    ds_read_b128 v[120:123], v204 offset:28672
    s_waitcnt lgkmcnt(7)
    v_mfma_f32_16x16x32_bf16 v[88:91], v[176:179], v[148:151], v[88:91]
    ds_read_b128 v[124:127], v204 offset:32768
    v_mfma_f32_16x16x32_bf16 v[108:111], v[148:151], v[180:183], v[108:111]
    ds_read_b64_tr_b16 v[168:169], v208 offset:8192
    s_waitcnt lgkmcnt(7)
    v_mfma_f32_16x16x32_bf16 v[64:67], v[172:175], v[144:147], v[64:67]
    ds_read_b64_tr_b16 v[170:171], v208 offset:8704
    v_mfma_f32_16x16x32_bf16 v[68:71], v[172:175], v[148:151], v[68:71]
    ds_read_b128 v[128:131], v204 offset:36864
    s_waitcnt lgkmcnt(8)
    v_mfma_f32_16x16x32_bf16 v[92:95], v[176:179], v[152:155], v[92:95]
    ds_read_b64_tr_b16 v[160:161], v208 offset:0
    v_mfma_f32_16x16x32_bf16 v[112:115], v[152:155], v[180:183], v[112:115]
    ds_read_b64_tr_b16 v[162:163], v208 offset:512
    v_mfma_f32_16x16x32_bf16 v[72:75], v[172:175], v[152:155], v[72:75]
    ds_read_b128 v[132:135], v204 offset:40960
    s_waitcnt lgkmcnt(10)
    v_mfma_f32_16x16x32_bf16 v[96:99], v[176:179], v[156:159], v[96:99]
    ds_read_b128 v[136:139], v204 offset:45056
    v_mfma_f32_16x16x32_bf16 v[116:119], v[156:159], v[180:183], v[116:119]
    v_mfma_f32_16x16x32_bf16 v[76:79], v[172:175], v[156:159], v[76:79]
    s_waitcnt lgkmcnt(8)
    v_mfma_f32_16x16x32_bf16 v[80:83], v[164:167], v[120:123], v[80:83]
    s_barrier
    s_waitcnt lgkmcnt(7)
    v_mfma_f32_16x16x32_bf16 v[84:87], v[164:167], v[124:127], v[84:87]
    ds_read_b64_tr_b16 v[176:177], v208 offset:16384
    s_waitcnt lgkmcnt(6)
    v_mfma_f32_16x16x32_bf16 v[100:103], v[120:123], v[168:171], v[100:103]
    ds_read_b64_tr_b16 v[178:179], v208 offset:16896
    v_mfma_f32_16x16x32_bf16 v[104:107], v[124:127], v[168:171], v[104:107]
    ds_read_b128 v[140:143], v205 offset:28672
    s_waitcnt lgkmcnt(7)
    v_mfma_f32_16x16x32_bf16 v[88:91], v[164:167], v[128:131], v[88:91]
    ds_read_b128 v[144:147], v205 offset:32768
    v_mfma_f32_16x16x32_bf16 v[108:111], v[128:131], v[168:171], v[108:111]
    ds_read_b64_tr_b16 v[180:181], v208 offset:20480
    s_waitcnt lgkmcnt(7)
    v_mfma_f32_16x16x32_bf16 v[64:67], v[160:163], v[124:127], v[64:67]
    ds_read_b64_tr_b16 v[182:183], v208 offset:20992
    v_mfma_f32_16x16x32_bf16 v[68:71], v[160:163], v[128:131], v[68:71]
    ds_read_b128 v[148:151], v205 offset:36864
    s_waitcnt lgkmcnt(8)
    v_mfma_f32_16x16x32_bf16 v[92:95], v[164:167], v[132:135], v[92:95]
    ds_read_b64_tr_b16 v[172:173], v208 offset:12288
    v_mfma_f32_16x16x32_bf16 v[112:115], v[132:135], v[168:171], v[112:115]
    ds_read_b64_tr_b16 v[174:175], v208 offset:12800
    v_mfma_f32_16x16x32_bf16 v[72:75], v[160:163], v[132:135], v[72:75]
    ds_read_b128 v[152:155], v205 offset:40960
    s_waitcnt lgkmcnt(10)
    v_mfma_f32_16x16x32_bf16 v[96:99], v[164:167], v[136:139], v[96:99]
    ds_read_b128 v[156:159], v205 offset:45056
    v_mfma_f32_16x16x32_bf16 v[116:119], v[136:139], v[168:171], v[116:119]
    v_mfma_f32_16x16x32_bf16 v[76:79], v[160:163], v[136:139], v[76:79]
    s_waitcnt lgkmcnt(8)
    v_mfma_f32_16x16x32_bf16 v[80:83], v[176:179], v[140:143], v[80:83]
    s_barrier
    s_waitcnt lgkmcnt(7)
    v_mfma_f32_16x16x32_bf16 v[84:87], v[176:179], v[144:147], v[84:87]
    ds_read_b64_tr_b16 v[164:165], v208 offset:28672
    s_waitcnt lgkmcnt(6)
    v_mfma_f32_16x16x32_bf16 v[100:103], v[140:143], v[180:183], v[100:103]
    ds_read_b64_tr_b16 v[166:167], v208 offset:29184
    v_mfma_f32_16x16x32_bf16 v[104:107], v[144:147], v[180:183], v[104:107]
    ds_read_b128 v[120:123], v206 offset:28672
    s_waitcnt lgkmcnt(7)
    v_mfma_f32_16x16x32_bf16 v[88:91], v[176:179], v[148:151], v[88:91]
    ds_read_b128 v[124:127], v206 offset:32768
    v_mfma_f32_16x16x32_bf16 v[108:111], v[148:151], v[180:183], v[108:111]
    ds_read_b64_tr_b16 v[168:169], v208 offset:32768
    s_waitcnt lgkmcnt(7)
    v_mfma_f32_16x16x32_bf16 v[64:67], v[172:175], v[144:147], v[64:67]
    ds_read_b64_tr_b16 v[170:171], v208 offset:33280
    v_mfma_f32_16x16x32_bf16 v[68:71], v[172:175], v[148:151], v[68:71]
    ds_read_b128 v[128:131], v206 offset:36864
    s_waitcnt lgkmcnt(8)
    v_mfma_f32_16x16x32_bf16 v[92:95], v[176:179], v[152:155], v[92:95]
    ds_read_b64_tr_b16 v[160:161], v208 offset:24576
    v_mfma_f32_16x16x32_bf16 v[112:115], v[152:155], v[180:183], v[112:115]
    ds_read_b64_tr_b16 v[162:163], v208 offset:25088
    v_mfma_f32_16x16x32_bf16 v[72:75], v[172:175], v[152:155], v[72:75]
    ds_read_b128 v[132:135], v206 offset:40960
    s_waitcnt lgkmcnt(10)
    v_mfma_f32_16x16x32_bf16 v[96:99], v[176:179], v[156:159], v[96:99]
    ds_read_b128 v[136:139], v206 offset:45056
    v_mfma_f32_16x16x32_bf16 v[116:119], v[156:159], v[180:183], v[116:119]
    v_mfma_f32_16x16x32_bf16 v[76:79], v[172:175], v[156:159], v[76:79]
    s_waitcnt lgkmcnt(8)
    v_mfma_f32_16x16x32_bf16 v[80:83], v[164:167], v[120:123], v[80:83]
    s_barrier
    s_waitcnt lgkmcnt(7)
    v_mfma_f32_16x16x32_bf16 v[84:87], v[164:167], v[124:127], v[84:87]
    ds_read_b64_tr_b16 v[176:177], v209 offset:4096
    s_waitcnt lgkmcnt(6)
    v_mfma_f32_16x16x32_bf16 v[100:103], v[120:123], v[168:171], v[100:103]
    ds_read_b64_tr_b16 v[178:179], v209 offset:4608
    v_mfma_f32_16x16x32_bf16 v[104:107], v[124:127], v[168:171], v[104:107]
    ds_read_b128 v[140:143], v207 offset:28672
    s_waitcnt lgkmcnt(7)
    v_mfma_f32_16x16x32_bf16 v[88:91], v[164:167], v[128:131], v[88:91]
    ds_read_b128 v[144:147], v207 offset:32768
    v_mfma_f32_16x16x32_bf16 v[108:111], v[128:131], v[168:171], v[108:111]
    ds_read_b64_tr_b16 v[180:181], v209 offset:8192
    s_waitcnt lgkmcnt(7)
    v_mfma_f32_16x16x32_bf16 v[64:67], v[160:163], v[124:127], v[64:67]
    ds_read_b64_tr_b16 v[182:183], v209 offset:8704
    v_mfma_f32_16x16x32_bf16 v[68:71], v[160:163], v[128:131], v[68:71]
    ds_read_b128 v[148:151], v207 offset:36864
    s_waitcnt lgkmcnt(8)
    v_mfma_f32_16x16x32_bf16 v[92:95], v[164:167], v[132:135], v[92:95]
    ds_read_b64_tr_b16 v[172:173], v209 offset:0
    v_mfma_f32_16x16x32_bf16 v[112:115], v[132:135], v[168:171], v[112:115]
    ds_read_b64_tr_b16 v[174:175], v209 offset:512
    v_mfma_f32_16x16x32_bf16 v[72:75], v[160:163], v[132:135], v[72:75]
    ds_read_b128 v[152:155], v207 offset:40960
    s_waitcnt lgkmcnt(10)
    v_mfma_f32_16x16x32_bf16 v[96:99], v[164:167], v[136:139], v[96:99]
    ds_read_b128 v[156:159], v207 offset:45056
    v_mfma_f32_16x16x32_bf16 v[116:119], v[136:139], v[168:171], v[116:119]
    v_mfma_f32_16x16x32_bf16 v[76:79], v[160:163], v[136:139], v[76:79]
    s_waitcnt lgkmcnt(8)
    v_mfma_f32_16x16x32_bf16 v[80:83], v[176:179], v[140:143], v[80:83]
    s_barrier
    s_waitcnt lgkmcnt(7)
    v_mfma_f32_16x16x32_bf16 v[84:87], v[176:179], v[144:147], v[84:87]
    s_waitcnt lgkmcnt(2)
    v_mfma_f32_16x16x32_bf16 v[64:67], v[172:175], v[144:147], v[64:67]
    v_mfma_f32_16x16x32_bf16 v[88:91], v[176:179], v[148:151], v[88:91]
    v_mfma_f32_16x16x32_bf16 v[68:71], v[172:175], v[148:151], v[68:71]
    s_waitcnt lgkmcnt(1)
    v_mfma_f32_16x16x32_bf16 v[92:95], v[176:179], v[152:155], v[92:95]
    v_mfma_f32_16x16x32_bf16 v[72:75], v[172:175], v[152:155], v[72:75]
    s_waitcnt lgkmcnt(0)
    v_mfma_f32_16x16x32_bf16 v[96:99], v[176:179], v[156:159], v[96:99]
    v_mfma_f32_16x16x32_bf16 v[76:79], v[172:175], v[156:159], v[76:79]
    v_cvt_pk_bf16_f32 v128, v80, v81
    v_cvt_pk_bf16_f32 v129, v82, v83
    v_cvt_pk_bf16_f32 v130, v84, v85
    v_mfma_f32_16x16x32_bf16 v[100:103], v[140:143], v[180:183], v[100:103]
    v_cvt_pk_bf16_f32 v131, v86, v87
    v_cvt_pk_bf16_f32 v120, v64, v65
    v_cvt_pk_bf16_f32 v121, v66, v67
    v_mfma_f32_16x16x32_bf16 v[104:107], v[144:147], v[180:183], v[104:107]
    v_cvt_pk_bf16_f32 v132, v88, v89
    v_cvt_pk_bf16_f32 v133, v90, v91
    v_cvt_pk_bf16_f32 v122, v68, v69
    v_mfma_f32_16x16x32_bf16 v[108:111], v[148:151], v[180:183], v[108:111]
    v_cvt_pk_bf16_f32 v123, v70, v71
    v_cvt_pk_bf16_f32 v134, v92, v93
    v_cvt_pk_bf16_f32 v135, v94, v95
    v_mfma_f32_16x16x32_bf16 v[112:115], v[152:155], v[180:183], v[112:115]
    v_cvt_pk_bf16_f32 v124, v72, v73
    v_cvt_pk_bf16_f32 v125, v74, v75
    v_cvt_pk_bf16_f32 v136, v96, v97
    v_mfma_f32_16x16x32_bf16 v[116:119], v[156:159], v[180:183], v[116:119]
    v_cvt_pk_bf16_f32 v137, v98, v99
    v_cvt_pk_bf16_f32 v126, v76, v77
    v_cvt_pk_bf16_f32 v127, v78, v79
    s_barrier
    v_mfma_f32_16x16x16_bf16 v[152:155], v[128:129], v[120:121], 0
    v_mfma_f32_16x16x16_bf16 v[168:171], v[130:131], v[120:121], 0
    v_mfma_f32_16x16x16_bf16 v[156:159], v[130:131], v[122:123], 0
    v_mfma_f32_16x16x16_bf16 v[172:175], v[132:133], v[122:123], 0
    v_cvt_pk_bf16_f32 v184, v100, v101
    v_cvt_pk_bf16_f32 v185, v102, v103
    v_mfma_f32_16x16x16_bf16 v[160:163], v[132:133], v[124:125], 0
    v_mfma_f32_16x16x16_bf16 v[176:179], v[134:135], v[124:125], 0
    v_cvt_pk_bf16_f32 v186, v104, v105
    v_cvt_pk_bf16_f32 v187, v106, v107
    v_mfma_f32_16x16x16_bf16 v[164:167], v[134:135], v[126:127], 0
    v_mfma_f32_16x16x16_bf16 v[180:183], v[136:137], v[126:127], 0
    v_cvt_pk_bf16_f32 v188, v108, v109
    v_cvt_pk_bf16_f32 v189, v110, v111
    v_cvt_pk_bf16_f32 v190, v112, v113
    v_cvt_pk_bf16_f32 v191, v114, v115
    v_cvt_pk_bf16_f32 v192, v116, v117
    v_cvt_pk_bf16_f32 v193, v118, v119
    s_cmp_lg_u32 s14, 0
    s_cbranch_scc1 L_nomask
    v_mov_b32 v152, 0xf149f2ca
    v_mov_b32 v153, 0xf149f2ca
    v_mov_b32 v154, 0xf149f2ca
    v_mov_b32 v155, 0xf149f2ca
L_nomask:
    v_cndmask_b32 v152, v152, v153, s[82:83]
    v_cndmask_b32 v154, v154, v155, s[82:83]
    v_cndmask_b32 v168, v168, v169, s[82:83]
    v_cndmask_b32 v170, v170, v171, s[82:83]
    v_cndmask_b32 v64, v152, v168, s[84:85]
    v_cndmask_b32 v65, v154, v170, s[86:87]
    v_cndmask_b32 v156, v156, v157, s[82:83]
    v_cndmask_b32 v158, v158, v159, s[82:83]
    v_cndmask_b32 v172, v172, v173, s[82:83]
    v_cndmask_b32 v174, v174, v175, s[82:83]
    v_cndmask_b32 v66, v156, v172, s[84:85]
    v_cndmask_b32 v67, v158, v174, s[86:87]
    v_cndmask_b32 v160, v160, v161, s[82:83]
    v_cndmask_b32 v162, v162, v163, s[82:83]
    v_cndmask_b32 v176, v176, v177, s[82:83]
    v_cndmask_b32 v178, v178, v179, s[82:83]
    v_cndmask_b32 v68, v160, v176, s[84:85]
    v_cndmask_b32 v69, v162, v178, s[86:87]
    v_cndmask_b32 v164, v164, v165, s[82:83]
    v_cndmask_b32 v166, v166, v167, s[82:83]
    v_cndmask_b32 v180, v180, v181, s[82:83]
    v_cndmask_b32 v182, v182, v183, s[82:83]
    v_cndmask_b32 v70, v164, v180, s[84:85]
    v_cndmask_b32 v71, v166, v182, s[86:87]
    v_max_f32 v72, v64, v65
    v_max_f32 v74, v66, v67
    v_max_f32 v76, v68, v69
    v_max_f32 v78, v70, v71
    s_mov_b32 s76, 0x3eb8aa3b
    s_nop 0
    v_permlane32_swap_b32 v72, v74
    v_permlane32_swap_b32 v76, v78
    v_max_f32 v72, v72, v74
    v_max_f32 v76, v76, v78
    s_nop 1
    v_permlane16_swap_b32 v72, v76
    v_max_f32 v72, v72, v76
    v_mul_f32 v72, s76, v72
    v_mov_b32 v76, v72
    s_nop 1
    v_permlane16_swap_b32 v72, v76
    v_mov_b32 v74, v72
    v_mov_b32 v78, v76
    s_nop 0
    v_permlane32_swap_b32 v72, v74
    v_permlane32_swap_b32 v76, v78
    v_fma_f32 v64, v64, s76, -v72
    v_fma_f32 v65, v65, s76, -v72
    v_fma_f32 v66, v66, s76, -v74
    v_fma_f32 v67, v67, s76, -v74
    v_fma_f32 v68, v68, s76, -v76
    v_fma_f32 v69, v69, s76, -v76
    v_fma_f32 v70, v70, s76, -v78
    v_fma_f32 v71, v71, s76, -v78
    v_exp_f32 v64, v64
    v_exp_f32 v65, v65
    v_exp_f32 v66, v66
    v_exp_f32 v67, v67
    v_exp_f32 v68, v68
    v_exp_f32 v69, v69
    v_exp_f32 v70, v70
    v_exp_f32 v71, v71
    v_cvt_pk_bf16_f32 v72, v64, v65
    v_cvt_pk_bf16_f32 v74, v66, v67
    v_cvt_pk_bf16_f32 v76, v68, v69
    v_cvt_pk_bf16_f32 v78, v70, v71
    v_perm_b32 v80, v72, v72, v210
    v_perm_b32 v81, v72, v72, v211
    v_perm_b32 v82, v72, v72, v212
    v_perm_b32 v83, v72, v72, v213
    v_perm_b32 v84, v74, v74, v210
    v_perm_b32 v85, v74, v74, v211
    v_perm_b32 v86, v74, v74, v212
    v_perm_b32 v87, v74, v74, v213
    v_mfma_f32_16x16x32_bf16 v[112:115], v[214:217], v[80:83], 0
    v_mfma_f32_16x16x32_bf16 v[96:99], v[184:187], v[80:83], 0
    v_perm_b32 v88, v76, v76, v210
    v_perm_b32 v89, v76, v76, v211
    v_perm_b32 v90, v76, v76, v212
    v_perm_b32 v91, v76, v76, v213
    v_mfma_f32_16x16x32_bf16 v[116:119], v[214:217], v[84:87], 0
    v_mfma_f32_16x16x32_bf16 v[100:103], v[186:189], v[84:87], 0
    v_perm_b32 v92, v78, v78, v210
    v_perm_b32 v93, v78, v78, v211
    v_perm_b32 v94, v78, v78, v212
    v_perm_b32 v95, v78, v78, v213
    v_mfma_f32_16x16x32_bf16 v[120:123], v[214:217], v[88:91], 0
    v_mfma_f32_16x16x32_bf16 v[104:107], v[188:191], v[88:91], 0
    s_lshl_b32 s76, s14, 16
    s_lshl_b32 s77, s15, 12
    v_mfma_f32_16x16x32_bf16 v[124:127], v[214:217], v[92:95], 0
    v_mfma_f32_16x16x32_bf16 v[108:111], v[190:193], v[92:95], 0
    s_add_u32 s76, s76, s77
    s_lshl_b32 s77, s3, 10
    s_add_u32 s76, s76, s77
    s_add_u32 s76, s76, 1048576
    s_add_u32 s77, s76, 32768
    v_rcp_f32 v112, v112
    v_rcp_f32 v116, v116
    v_rcp_f32 v120, v120
    v_rcp_f32 v124, v124
    v_pk_mul_f32 v[96:97], v[96:97], v[112:113] op_sel_hi:[1,0]
    v_pk_mul_f32 v[98:99], v[98:99], v[112:113] op_sel_hi:[1,0]
    v_pk_mul_f32 v[100:101], v[100:101], v[116:117] op_sel_hi:[1,0]
    v_pk_mul_f32 v[102:103], v[102:103], v[116:117] op_sel_hi:[1,0]
    v_pk_mul_f32 v[104:105], v[104:105], v[120:121] op_sel_hi:[1,0]
    v_pk_mul_f32 v[106:107], v[106:107], v[120:121] op_sel_hi:[1,0]
    v_pk_mul_f32 v[108:109], v[108:109], v[124:125] op_sel_hi:[1,0]
    v_pk_mul_f32 v[110:111], v[110:111], v[124:125] op_sel_hi:[1,0]
    v_cvt_pk_bf16_f32 v64, v96, v97
    v_cvt_pk_bf16_f32 v65, v98, v99
    v_cvt_pk_bf16_f32 v66, v100, v101
    v_cvt_pk_bf16_f32 v67, v102, v103
    v_cvt_pk_bf16_f32 v68, v104, v105
    v_cvt_pk_bf16_f32 v69, v106, v107
    v_cvt_pk_bf16_f32 v70, v108, v109
    v_cvt_pk_bf16_f32 v71, v110, v111
    s_nop 0
    v_permlane32_swap_b32 v64, v66
    v_permlane32_swap_b32 v65, v67
    buffer_store_dwordx4 v[64:67], v222, s[60:63], s76 offen sc1
    v_permlane32_swap_b32 v68, v70
    v_permlane32_swap_b32 v69, v71
    buffer_store_dwordx4 v[68:71], v222, s[60:63], s77 offen sc1
    s_and_b32 s77, s3, 1
    s_lshr_b32 s79, s3, 1
    v_lshrrev_b32 v15, 5, v1
    s_lshl_b32 s76, s6, 1
    s_add_u32 s76, s76, s77
    s_lshl_b32 s78, s76, 15
    s_lshl_b32 s76, s7, 1
    s_add_u32 s76, s76, s79
    s_lshl_b32 s90, s76, 11
    s_add_u32 s90, s90, s78
    s_add_u32 s90, s90, 3145728
    s_lshl_b32 s23, s7, 2
    s_lshl_b32 s88, s73, 7
    s_add_u32 s23, s23, s88
    s_add_u32 s23, s23, s89
    s_add_u32 s23, s23, 256
    s_lshl_b32 s88, s79, 14
    s_add_u32 s78, s78, s88
    s_add_u32 s78, s78, 1048576
    v_and_b32 v14, 15, v1
    v_bfe_u32 v13, v1, 4, 1
    v_bfe_u32 v9, v14, 1, 1
    v_lshl_or_b32 v13, v13, 1, v9
    s_lshl_b32 s76, s79, 2
    v_or_b32 v13, s76, v13
    v_lshrrev_b32 v9, 3, v14
    v_lshlrev_b32 v9, 2, v9
    v_xor_b32 v13, v13, v9
    v_lshlrev_b32 v13, 4, v13
    v_lshrrev_b32 v9, 2, v14
    v_lshl_add_u32 v13, v9, 7, v13
    v_and_b32 v9, 1, v14
    v_lshl_add_u32 v13, v9, 3, v13
    v_lshl_add_u32 v13, v15, 9, v13
    s_lshl_b32 s76, s79, 15
    s_add_u32 s76, s76, 8192
    v_add_u32 v9, s76, v13
    v_xor_b32 v10, 64, v9
    v_lshlrev_b32 v12, 4, v15
    s_lshl_b32 s88, s79, 7
    v_add_u32 v12, s88, v12
    s_lshl_b32 s91, s6, 1
    s_add_u32 s91, s91, s77
    s_mul_i32 s91, s91, 114688
    s_lshl_b32 s88, s79, 11
    s_add_u32 s91, s91, s88
    s_add_u32 s91, s91, 5242880
    s_lshr_b32 s76, s14, 1
    s_lshl_b32 s76, s76, 11
    s_and_b32 s88, s14, 1
    s_lshl_b32 s88, s88, 7
    s_add_u32 s76, s76, s88
    s_lshl_b32 s88, s15, 2
    s_add_u32 s76, s76, s88
    s_add_u32 s76, s76, 4096
    s_waitcnt vmcnt(0)
    s_barrier
    s_cmp_eq_u32 s3, 1
    s_cbranch_scc0 L_nfo
    v_mov_b32 v14, 0
    v_mov_b32 v15, s68
    s_mov_b64 exec, 1
    buffer_store_dword v15, v14, s[60:63], s76 offen sc1
    s_mov_b64 exec, -1
L_nfo:
    ds_read_b64_tr_b16 v[128:129], v9 offset:0
    ds_read_b64_tr_b16 v[130:131], v9 offset:1024
    ds_read_b64_tr_b16 v[192:193], v10 offset:0
    ds_read_b64_tr_b16 v[194:195], v10 offset:1024
    ds_read_b64_tr_b16 v[132:133], v9 offset:2048
    ds_read_b64_tr_b16 v[134:135], v9 offset:3072
    ds_read_b64_tr_b16 v[196:197], v10 offset:2048
    ds_read_b64_tr_b16 v[198:199], v10 offset:3072
    ds_read_b64_tr_b16 v[136:137], v9 offset:4096
    ds_read_b64_tr_b16 v[138:139], v9 offset:5120
    ds_read_b64_tr_b16 v[200:201], v10 offset:4096
    ds_read_b64_tr_b16 v[202:203], v10 offset:5120
    ds_read_b64_tr_b16 v[140:141], v9 offset:6144
    ds_read_b64_tr_b16 v[142:143], v9 offset:7168
    ds_read_b64_tr_b16 v[204:205], v10 offset:6144
    ds_read_b64_tr_b16 v[206:207], v10 offset:7168
    ds_read_b64_tr_b16 v[144:145], v9 offset:8192
    ds_read_b64_tr_b16 v[146:147], v9 offset:9216
    ds_read_b64_tr_b16 v[208:209], v10 offset:8192
    ds_read_b64_tr_b16 v[210:211], v10 offset:9216
    ds_read_b64_tr_b16 v[148:149], v9 offset:10240
    ds_read_b64_tr_b16 v[150:151], v9 offset:11264
    ds_read_b64_tr_b16 v[212:213], v10 offset:10240
    ds_read_b64_tr_b16 v[214:215], v10 offset:11264
    ds_read_b64_tr_b16 v[152:153], v9 offset:12288
    ds_read_b64_tr_b16 v[154:155], v9 offset:13312
    ds_read_b64_tr_b16 v[216:217], v10 offset:12288
    ds_read_b64_tr_b16 v[218:219], v10 offset:13312
    ds_read_b64_tr_b16 v[156:157], v9 offset:14336
    ds_read_b64_tr_b16 v[158:159], v9 offset:15360
    ds_read_b64_tr_b16 v[220:221], v10 offset:14336
    ds_read_b64_tr_b16 v[222:223], v10 offset:15360
    ds_read_b64_tr_b16 v[160:161], v9 offset:16384
    ds_read_b64_tr_b16 v[162:163], v9 offset:17408
    ds_read_b64_tr_b16 v[224:225], v10 offset:16384
    ds_read_b64_tr_b16 v[226:227], v10 offset:17408
    ds_read_b64_tr_b16 v[164:165], v9 offset:18432
    ds_read_b64_tr_b16 v[166:167], v9 offset:19456
    ds_read_b64_tr_b16 v[228:229], v10 offset:18432
    ds_read_b64_tr_b16 v[230:231], v10 offset:19456
    ds_read_b64_tr_b16 v[168:169], v9 offset:20480
    ds_read_b64_tr_b16 v[170:171], v9 offset:21504
    ds_read_b64_tr_b16 v[232:233], v10 offset:20480
    ds_read_b64_tr_b16 v[234:235], v10 offset:21504
    ds_read_b64_tr_b16 v[172:173], v9 offset:22528
    ds_read_b64_tr_b16 v[174:175], v9 offset:23552
    ds_read_b64_tr_b16 v[236:237], v10 offset:22528
    ds_read_b64_tr_b16 v[238:239], v10 offset:23552
    ds_read_b64_tr_b16 v[176:177], v9 offset:24576
    ds_read_b64_tr_b16 v[178:179], v9 offset:25600
    ds_read_b64_tr_b16 v[240:241], v10 offset:24576
    ds_read_b64_tr_b16 v[242:243], v10 offset:25600
    ds_read_b64_tr_b16 v[180:181], v9 offset:26624
    ds_read_b64_tr_b16 v[182:183], v9 offset:27648
    ds_read_b64_tr_b16 v[244:245], v10 offset:26624
    ds_read_b64_tr_b16 v[246:247], v10 offset:27648
    ds_read_b64_tr_b16 v[184:185], v9 offset:28672
    ds_read_b64_tr_b16 v[186:187], v9 offset:29696
    ds_read_b64_tr_b16 v[248:249], v10 offset:28672
    ds_read_b64_tr_b16 v[250:251], v10 offset:29696
    ds_read_b64_tr_b16 v[188:189], v9 offset:30720
    ds_read_b64_tr_b16 v[190:191], v9 offset:31744
    ds_read_b64_tr_b16 v[252:253], v10 offset:30720
    ds_read_b64_tr_b16 v[254:255], v10 offset:31744
    s_lshl_b32 s76, s79, 12
    s_add_u32 s76, s76, 8192
    v_add_u32 v9, s76, v13
    s_cmp_eq_u32 s3, 0
    s_cbranch_scc0 L_po_n
    s_lshl_b32 s77, s73, 7
    s_add_u32 s77, s77, s89
    v_and_b32 v14, 7, v1
    v_lshrrev_b32 v15, 3, v1
    v_lshlrev_b32 v15, 7, v15
    v_lshl_add_u32 v14, v14, 2, v15
    s_mov_b64 exec, 0xff
    s_mov_b32 s88, 0
L_po:
    s_sleep 8
    buffer_load_dword v15, v14, s[60:63], s77 offen sc1
    s_add_u32 s88, s88, 1
    s_cmp_gt_u32 s88, 0x40000
    s_cbranch_scc1 L_po_x
    s_waitcnt vmcnt(0)
    v_cmp_ne_u32 vcc, s68, v15
    s_cbranch_vccnz L_po
L_po_x:
    s_mov_b64 exec, -1
L_po_n:
    s_waitcnt lgkmcnt(0)
    s_barrier
    s_mov_b32 s84, s78
    s_lshl_b32 s85, s7, 11
    s_add_u32 s79, s84, s85
    s_add_u32 s85, s85, 2048
    s_and_b32 s85, s85, 0x3fff
    buffer_load_dwordx4 v[64:67], v8, s[60:63], s79 offen offset:0 sc1
    buffer_load_dwordx4 v[68:71], v8, s[60:63], s79 offen offset:1024 sc1
    s_add_u32 s79, s84, s85
    s_add_u32 s85, s85, 2048
    s_and_b32 s85, s85, 0x3fff
    buffer_load_dwordx4 v[72:75], v8, s[60:63], s79 offen offset:0 sc1
    buffer_load_dwordx4 v[76:79], v8, s[60:63], s79 offen offset:1024 sc1
    s_add_u32 s79, s84, s85
    s_add_u32 s85, s85, 2048
    s_and_b32 s85, s85, 0x3fff
    buffer_load_dwordx4 v[80:83], v8, s[60:63], s79 offen offset:0 sc1
    buffer_load_dwordx4 v[84:87], v8, s[60:63], s79 offen offset:1024 sc1
    s_add_u32 s79, s84, s85
    s_add_u32 s85, s85, 2048
    s_and_b32 s85, s85, 0x3fff
    buffer_load_dwordx4 v[88:91], v8, s[60:63], s79 offen offset:0 sc1
    buffer_load_dwordx4 v[92:95], v8, s[60:63], s79 offen offset:1024 sc1
    v_permlane32_swap_b32 v24, v26
    v_permlane32_swap_b32 v25, v27
    v_permlane32_swap_b32 v28, v30
    v_permlane32_swap_b32 v29, v31
    s_lshl_b32 s76, s3, 12
    s_add_u32 s76, s76, 147456
    s_xor_b32 s77, s3, 2
    s_lshl_b32 s78, s77, 12
    s_add_u32 s78, s78, 147456
    v_add_u32 v10, s76, v8
    v_add_u32 v13, s78, v8
    s_waitcnt vmcnt(7)
    v_mfma_f32_32x32x16_bf16 v[48:63], v[192:195], v[64:67], 0
    s_add_u32 s79, s84, s85
    s_add_u32 s85, s85, 2048
    s_and_b32 s85, s85, 0x3fff
    buffer_load_dwordx4 v[96:99], v8, s[60:63], s79 offen offset:0 sc1
    v_mfma_f32_32x32x16_bf16 v[32:47], v[128:131], v[64:67], 0
    s_waitcnt vmcnt(7)
    v_mfma_f32_32x32x16_bf16 v[48:63], v[196:199], v[68:71], v[48:63]
    buffer_load_dwordx4 v[100:103], v8, s[60:63], s79 offen offset:1024 sc1
    v_mfma_f32_32x32x16_bf16 v[32:47], v[132:135], v[68:71], v[32:47]
    s_waitcnt vmcnt(7)
    v_mfma_f32_32x32x16_bf16 v[48:63], v[200:203], v[72:75], v[48:63]
    s_add_u32 s79, s84, s85
    s_add_u32 s85, s85, 2048
    s_and_b32 s85, s85, 0x3fff
    buffer_load_dwordx4 v[104:107], v8, s[60:63], s79 offen offset:0 sc1
    v_mfma_f32_32x32x16_bf16 v[32:47], v[136:139], v[72:75], v[32:47]
    s_waitcnt vmcnt(7)
    v_mfma_f32_32x32x16_bf16 v[48:63], v[204:207], v[76:79], v[48:63]
    buffer_load_dwordx4 v[108:111], v8, s[60:63], s79 offen offset:1024 sc1
    v_mfma_f32_32x32x16_bf16 v[32:47], v[140:143], v[76:79], v[32:47]
    s_waitcnt vmcnt(7)
    v_mfma_f32_32x32x16_bf16 v[48:63], v[208:211], v[80:83], v[48:63]
    s_add_u32 s79, s84, s85
    s_add_u32 s85, s85, 2048
    s_and_b32 s85, s85, 0x3fff
    buffer_load_dwordx4 v[112:115], v8, s[60:63], s79 offen offset:0 sc1
    v_mfma_f32_32x32x16_bf16 v[32:47], v[144:147], v[80:83], v[32:47]
    s_waitcnt vmcnt(7)
    v_mfma_f32_32x32x16_bf16 v[48:63], v[212:215], v[84:87], v[48:63]
    buffer_load_dwordx4 v[116:119], v8, s[60:63], s79 offen offset:1024 sc1
    v_mfma_f32_32x32x16_bf16 v[32:47], v[148:151], v[84:87], v[32:47]
    s_waitcnt vmcnt(7)
    v_mfma_f32_32x32x16_bf16 v[48:63], v[216:219], v[88:91], v[48:63]
    s_add_u32 s79, s84, s85
    s_add_u32 s85, s85, 2048
    s_and_b32 s85, s85, 0x3fff
    buffer_load_dwordx4 v[120:123], v8, s[60:63], s79 offen offset:0 sc1
    v_mfma_f32_32x32x16_bf16 v[32:47], v[152:155], v[88:91], v[32:47]
    s_waitcnt vmcnt(7)
    v_mfma_f32_32x32x16_bf16 v[48:63], v[220:223], v[92:95], v[48:63]
    buffer_load_dwordx4 v[124:127], v8, s[60:63], s79 offen offset:1024 sc1
    v_mfma_f32_32x32x16_bf16 v[32:47], v[156:159], v[92:95], v[32:47]
    s_waitcnt vmcnt(7)
    v_mfma_f32_32x32x16_bf16 v[48:63], v[224:227], v[96:99], v[48:63]
    v_mfma_f32_32x32x16_bf16 v[32:47], v[160:163], v[96:99], v[32:47]
    s_waitcnt vmcnt(6)
    v_mfma_f32_32x32x16_bf16 v[48:63], v[228:231], v[100:103], v[48:63]
    v_mfma_f32_32x32x16_bf16 v[32:47], v[164:167], v[100:103], v[32:47]
    s_waitcnt vmcnt(5)
    v_mfma_f32_32x32x16_bf16 v[48:63], v[232:235], v[104:107], v[48:63]
    v_mfma_f32_32x32x16_bf16 v[32:47], v[168:171], v[104:107], v[32:47]
    s_waitcnt vmcnt(4)
    v_mfma_f32_32x32x16_bf16 v[48:63], v[236:239], v[108:111], v[48:63]
    v_mfma_f32_32x32x16_bf16 v[32:47], v[172:175], v[108:111], v[32:47]
    s_waitcnt vmcnt(3)
    v_mfma_f32_32x32x16_bf16 v[48:63], v[240:243], v[112:115], v[48:63]
    v_mfma_f32_32x32x16_bf16 v[32:47], v[176:179], v[112:115], v[32:47]
    s_waitcnt vmcnt(2)
    v_mfma_f32_32x32x16_bf16 v[48:63], v[244:247], v[116:119], v[48:63]
    s_waitcnt vmcnt(1)
    v_mfma_f32_32x32x16_bf16 v[48:63], v[248:251], v[120:123], v[48:63]
    s_waitcnt vmcnt(0)
    v_mfma_f32_32x32x16_bf16 v[48:63], v[252:255], v[124:127], v[48:63]
    v_mfma_f32_32x32x16_bf16 v[32:47], v[180:183], v[116:119], v[32:47]
    v_mfma_f32_32x32x16_bf16 v[32:47], v[184:187], v[120:123], v[32:47]
    v_mfma_f32_32x32x16_bf16 v[32:47], v[188:191], v[124:127], v[32:47]
    s_lshl_b32 s77, s4, 4
    s_lshl_b32 s76, s7, 1
    s_add_u32 s77, s77, s76
    s_lshr_b32 s76, s3, 1
    s_add_u32 s77, s77, s76
    s_lshl_b32 s77, s77, 2
    s_lshl_b32 s76, s73, 1
    s_add_u32 s77, s77, s76
    s_and_b32 s76, s3, 1
    s_add_u32 s77, s77, s76
    s_lshl_b32 s77, s77, 8
    s_add_u32 s77, s77, 131072
    v_and_b32 v14, 31, v1
    v_lshrrev_b32 v15, 5, v1
    v_lshlrev_b32 v15, 2, v15
    v_lshl_add_u32 v3, v14, 3, v15
    v_lshlrev_b32 v192, 16, v24
    v_and_b32 v193, 0xffff0000, v24
    v_lshlrev_b32 v194, 16, v25
    v_and_b32 v195, 0xffff0000, v25
    v_lshlrev_b32 v196, 16, v26
    v_and_b32 v197, 0xffff0000, v26
    v_lshlrev_b32 v198, 16, v27
    v_and_b32 v199, 0xffff0000, v27
    v_lshlrev_b32 v200, 16, v28
    v_and_b32 v201, 0xffff0000, v28
    v_lshlrev_b32 v202, 16, v29
    v_and_b32 v203, 0xffff0000, v29
    v_lshlrev_b32 v204, 16, v30
    v_and_b32 v205, 0xffff0000, v30
    v_lshlrev_b32 v206, 16, v31
    v_and_b32 v207, 0xffff0000, v31
    ds_write_b128 v10, v[48:51] offset:0
    ds_write_b128 v10, v[52:55] offset:1024
    ds_write_b128 v10, v[56:59] offset:2048
    ds_write_b128 v10, v[60:63] offset:3072
    s_waitcnt lgkmcnt(0)
    s_barrier
    ds_read_b128 v[96:99], v13 offset:0
    ds_read_b128 v[100:103], v13 offset:1024
    ds_read_b128 v[104:107], v13 offset:2048
    ds_read_b128 v[108:111], v13 offset:3072
    ds_read_b128 v[64:67], v12 offset:4352
    ds_read_b128 v[68:71], v12 offset:4384
    ds_read_b128 v[72:75], v12 offset:4416
    ds_read_b128 v[76:79], v12 offset:4448
    ds_read_b128 v[80:83], v12 offset:4608
    ds_read_b128 v[84:87], v12 offset:4640
    ds_read_b128 v[88:91], v12 offset:4672
    ds_read_b128 v[92:95], v12 offset:4704
    s_waitcnt lgkmcnt(8)
    v_pk_add_f32 v[96:97], v[96:97], v[32:33]
    v_pk_add_f32 v[98:99], v[98:99], v[34:35]
    v_pk_add_f32 v[100:101], v[100:101], v[36:37]
    v_pk_add_f32 v[102:103], v[102:103], v[38:39]
    v_pk_add_f32 v[104:105], v[104:105], v[40:41]
    v_pk_add_f32 v[106:107], v[106:107], v[42:43]
    v_pk_add_f32 v[108:109], v[108:109], v[44:45]
    v_pk_add_f32 v[110:111], v[110:111], v[46:47]
    s_waitcnt lgkmcnt(0)
    v_pk_fma_f32 v[192:193], v[64:65], v[96:97], v[192:193]
    v_pk_fma_f32 v[194:195], v[66:67], v[98:99], v[194:195]
    v_pk_fma_f32 v[196:197], v[68:69], v[100:101], v[196:197]
    v_pk_fma_f32 v[198:199], v[70:71], v[102:103], v[198:199]
    v_pk_mul_f32 v[96:97], v[192:193], v[80:81]
    v_pk_mul_f32 v[98:99], v[194:195], v[82:83]
    v_pk_mul_f32 v[100:101], v[196:197], v[84:85]
    v_pk_mul_f32 v[102:103], v[198:199], v[86:87]
    v_cvt_pk_bf16_f32 v24, v96, v97
    v_cvt_pk_bf16_f32 v25, v98, v99
    v_cvt_pk_bf16_f32 v26, v100, v101
    v_cvt_pk_bf16_f32 v27, v102, v103
    buffer_store_dwordx4 v[24:27], v8, s[60:63], s90 offen offset:0 sc1
    v_pk_fma_f32 v[200:201], v[72:73], v[104:105], v[200:201]
    v_pk_fma_f32 v[202:203], v[74:75], v[106:107], v[202:203]
    v_pk_fma_f32 v[204:205], v[76:77], v[108:109], v[204:205]
    v_pk_fma_f32 v[206:207], v[78:79], v[110:111], v[206:207]
    v_pk_mul_f32 v[104:105], v[200:201], v[88:89]
    v_pk_mul_f32 v[106:107], v[202:203], v[90:91]
    v_pk_mul_f32 v[108:109], v[204:205], v[92:93]
    v_pk_mul_f32 v[110:111], v[206:207], v[94:95]
    v_cvt_pk_bf16_f32 v28, v104, v105
    v_cvt_pk_bf16_f32 v29, v106, v107
    v_cvt_pk_bf16_f32 v30, v108, v109
    v_cvt_pk_bf16_f32 v31, v110, v111
    buffer_store_dwordx4 v[28:31], v8, s[60:63], s90 offen offset:1024 sc1
    v_pk_mul_f32 v[96:97], v[192:193], v[192:193]
    v_pk_add_f32 v[98:99], v[192:193], v[194:195]
    v_pk_fma_f32 v[96:97], v[194:195], v[194:195], v[96:97]
    v_pk_fma_f32 v[96:97], v[196:197], v[196:197], v[96:97]
    v_pk_add_f32 v[98:99], v[98:99], v[196:197]
    v_pk_fma_f32 v[96:97], v[198:199], v[198:199], v[96:97]
    v_pk_add_f32 v[98:99], v[98:99], v[198:199]
    v_pk_fma_f32 v[96:97], v[200:201], v[200:201], v[96:97]
    v_pk_add_f32 v[98:99], v[98:99], v[200:201]
    v_pk_fma_f32 v[96:97], v[202:203], v[202:203], v[96:97]
    v_pk_add_f32 v[98:99], v[98:99], v[202:203]
    v_pk_fma_f32 v[96:97], v[204:205], v[204:205], v[96:97]
    v_pk_add_f32 v[98:99], v[98:99], v[204:205]
    v_pk_fma_f32 v[96:97], v[206:207], v[206:207], v[96:97]
    v_pk_add_f32 v[98:99], v[98:99], v[206:207]
    v_add_f32 v97, v96, v97
    v_add_f32 v96, v98, v99
    s_nop 1
    v_permlane32_swap_b32 v96, v97
    v_add_f32 v96, v96, v97
    buffer_store_dword v96, v3, s[60:63], s77 offen sc1
    v_cvt_pk_bf16_f32 v16, v192, v193
    v_cvt_pk_bf16_f32 v17, v194, v195
    v_cvt_pk_bf16_f32 v18, v196, v197
    v_cvt_pk_bf16_f32 v19, v198, v199
    v_cvt_pk_bf16_f32 v20, v200, v201
    v_cvt_pk_bf16_f32 v21, v202, v203
    v_cvt_pk_bf16_f32 v22, v204, v205
    v_cvt_pk_bf16_f32 v23, v206, v207
    s_and_b32 s76, s6, 3
    s_mul_i32 s76, s76, 3
    s_lshl_b32 s88, s7, 1
    s_add_u32 s76, s76, s88
    s_sub_u32 s88, s76, 14
    s_cmp_ge_u32 s76, 14
    s_cselect_b32 s76, s88, s76
    s_lshl_b32 s86, s76, 13
    v_and_b32 v14, 15, v1
    v_bfe_u32 v15, v1, 4, 1
    v_lshrrev_b32 v10, 3, v14
    v_lshl_or_b32 v10, v15, 1, v10
    v_lshlrev_b32 v13, 12, v15
    v_lshrrev_b32 v15, 2, v14
    v_lshl_add_u32 v13, v15, 7, v13
    v_lshrrev_b32 v15, 5, v1
    v_lshl_add_u32 v13, v15, 9, v13
    v_and_b32 v15, 3, v14
    v_lshl_add_u32 v13, v15, 3, v13
    v_add_u32 v13, 8192, v13
    s_lshl_b32 s78, s56, 2
    s_add_u32 s78, s78, s3
    s_mul_i32 s90, s78, 114688
    s_lshl_b32 s76, s57, 13
    s_add_u32 s90, s90, s76
    s_add_u32 s90, s90, 5242880
    s_lshl_b32 s78, s78, 15
    s_add_u32 s78, s78, 3145728
    s_waitcnt vmcnt(0)
    s_barrier
    s_cmp_eq_u32 s3, 1
    s_cbranch_scc0 L_nfy
    v_lshlrev_b32 v14, 8, v1
    v_mov_b32 v15, s68
    s_mov_b64 exec, 3
    buffer_store_dword v15, v14, s[60:63], s23 offen sc1
    s_mov_b64 exec, -1
L_nfy:
    v_xor_b32 v15, 0, v10
    v_lshl_add_u32 v24, v15, 5, v13
    v_xor_b32 v15, 1, v10
    v_lshl_add_u32 v25, v15, 5, v13
    v_xor_b32 v15, 2, v10
    v_lshl_add_u32 v26, v15, 5, v13
    v_xor_b32 v15, 3, v10
    v_lshl_add_u32 v27, v15, 5, v13
    v_and_b32 v10, 31, v1
    v_lshlrev_b32 v10, 4, v10
    s_cmp_ge_u32 s57, 14
    s_cbranch_scc1 L_p3s
    v_add_u32 v24, 65536, v24
    ds_read_b64_tr_b16 v[32:33], v24 offset:0
    ds_read_b64_tr_b16 v[34:35], v24 offset:1024
    v_add_u32 v25, 65536, v25
    ds_read_b64_tr_b16 v[36:37], v25 offset:0
    ds_read_b64_tr_b16 v[38:39], v25 offset:1024
    v_add_u32 v26, 65536, v26
    ds_read_b64_tr_b16 v[40:41], v26 offset:0
    ds_read_b64_tr_b16 v[42:43], v26 offset:1024
    v_add_u32 v27, 65536, v27
    ds_read_b64_tr_b16 v[44:45], v27 offset:0
    ds_read_b64_tr_b16 v[46:47], v27 offset:1024
    ds_read_b64_tr_b16 v[48:49], v24 offset:2048
    ds_read_b64_tr_b16 v[50:51], v24 offset:3072
    ds_read_b64_tr_b16 v[52:53], v25 offset:2048
    ds_read_b64_tr_b16 v[54:55], v25 offset:3072
    ds_read_b64_tr_b16 v[56:57], v26 offset:2048
    ds_read_b64_tr_b16 v[58:59], v26 offset:3072
    s_cmp_eq_u32 s3, 0
    s_cbranch_scc0 L_py_n
    s_and_b32 s77, s2, 1
    s_lshl_b32 s77, s77, 8
    s_add_u32 s77, s77, s58
    s_add_u32 s77, s77, 256
    v_and_b32 v14, 7, v1
    v_lshrrev_b32 v15, 3, v1
    v_lshlrev_b32 v15, 7, v15
    v_lshl_add_u32 v14, v14, 2, v15
    s_mov_b64 exec, 0xffff
    s_mov_b32 s88, 0
L_py:
    s_sleep 14
    buffer_load_dword v15, v14, s[60:63], s77 offen sc1
    s_add_u32 s88, s88, 1
    s_cmp_gt_u32 s88, 0x40000
    s_cbranch_scc1 L_py_x
    s_waitcnt vmcnt(0)
    v_cmp_ne_u32 vcc, s68, v15
    s_cbranch_vccnz L_py
L_py_x:
    s_mov_b64 exec, -1
L_py_n:
    v_and_b32 v14, 31, v1
    v_lshrrev_b32 v15, 5, v1
    v_lshlrev_b32 v15, 13, v15
    v_lshl_add_u32 v14, v14, 3, v15
    s_lshl_b32 s79, s56, 14
    s_lshl_b32 s76, s3, 8
    s_add_u32 s79, s79, s76
    s_add_u32 s79, s79, 131072
    s_barrier
    s_lshl_b32 s84, s28, 11
    s_add_u32 s77, s78, s84
    s_add_u32 s84, s84, 2048
    s_and_b32 s84, s84, 0x7fff
    buffer_load_dwordx4 v[128:131], v8, s[60:63], s77 offen offset:0 sc1
    buffer_load_dwordx4 v[132:135], v8, s[60:63], s77 offen offset:1024 sc1
    s_add_u32 s77, s78, s84
    s_add_u32 s84, s84, 2048
    s_and_b32 s84, s84, 0x7fff
    buffer_load_dwordx4 v[136:139], v8, s[60:63], s77 offen offset:0 sc1
    buffer_load_dwordx2 v[240:241], v14, s[60:63], s79 offen offset:0 sc1
    buffer_load_dwordx2 v[242:243], v14, s[60:63], s79 offen offset:1024 sc1
    buffer_load_dwordx2 v[244:245], v14, s[60:63], s79 offen offset:2048 sc1
    buffer_load_dwordx2 v[246:247], v14, s[60:63], s79 offen offset:3072 sc1
    s_add_u32 s79, s79, 4096
    buffer_load_dwordx2 v[248:249], v14, s[60:63], s79 offen offset:0 sc1
    buffer_load_dwordx2 v[250:251], v14, s[60:63], s79 offen offset:1024 sc1
    buffer_load_dwordx2 v[252:253], v14, s[60:63], s79 offen offset:2048 sc1
    buffer_load_dwordx2 v[254:255], v14, s[60:63], s79 offen offset:3072 sc1
    buffer_load_dwordx4 v[140:143], v8, s[60:63], s77 offen offset:1024 sc1
    s_add_u32 s77, s78, s84
    s_add_u32 s84, s84, 2048
    s_and_b32 s84, s84, 0x7fff
    buffer_load_dwordx4 v[144:147], v8, s[60:63], s77 offen offset:0 sc1
    buffer_load_dwordx4 v[148:151], v8, s[60:63], s77 offen offset:1024 sc1
    s_waitcnt vmcnt(13)
    s_waitcnt lgkmcnt(12)
    v_mfma_f32_32x32x16_bf16 v[64:79], v[32:35], v[128:131], 0
    ds_read_b64_tr_b16 v[60:61], v27 offset:2048
    ds_read_b64_tr_b16 v[62:63], v27 offset:3072
    s_waitcnt lgkmcnt(12)
    v_mfma_f32_32x32x16_bf16 v[80:95], v[36:39], v[128:131], 0
    s_add_u32 s77, s78, s84
    s_add_u32 s84, s84, 2048
    s_and_b32 s84, s84, 0x7fff
    buffer_load_dwordx4 v[152:155], v8, s[60:63], s77 offen offset:0 sc1
    ds_read_b64_tr_b16 v[32:33], v24 offset:8192
    ds_read_b64_tr_b16 v[34:35], v24 offset:9216
    s_waitcnt lgkmcnt(12)
    v_mfma_f32_32x32x16_bf16 v[96:111], v[40:43], v[128:131], 0
    ds_read_b64_tr_b16 v[36:37], v25 offset:8192
    ds_read_b64_tr_b16 v[38:39], v25 offset:9216
    s_waitcnt lgkmcnt(12)
    v_mfma_f32_32x32x16_bf16 v[112:127], v[44:47], v[128:131], 0
    ds_read_b64_tr_b16 v[40:41], v26 offset:8192
    ds_read_b64_tr_b16 v[42:43], v26 offset:9216
    s_waitcnt vmcnt(13)
    s_waitcnt lgkmcnt(12)
    v_mfma_f32_32x32x16_bf16 v[64:79], v[48:51], v[132:135], v[64:79]
    ds_read_b64_tr_b16 v[44:45], v27 offset:8192
    ds_read_b64_tr_b16 v[46:47], v27 offset:9216
    s_waitcnt lgkmcnt(12)
    v_mfma_f32_32x32x16_bf16 v[80:95], v[52:55], v[132:135], v[80:95]
    buffer_load_dwordx4 v[156:159], v8, s[60:63], s77 offen offset:1024 sc1
    ds_read_b64_tr_b16 v[48:49], v24 offset:10240
    ds_read_b64_tr_b16 v[50:51], v24 offset:11264
    s_waitcnt lgkmcnt(12)
    v_mfma_f32_32x32x16_bf16 v[96:111], v[56:59], v[132:135], v[96:111]
    ds_read_b64_tr_b16 v[52:53], v25 offset:10240
    ds_read_b64_tr_b16 v[54:55], v25 offset:11264
    s_waitcnt lgkmcnt(12)
    v_mfma_f32_32x32x16_bf16 v[112:127], v[60:63], v[132:135], v[112:127]
    ds_read_b64_tr_b16 v[56:57], v26 offset:10240
    ds_read_b64_tr_b16 v[58:59], v26 offset:11264
    s_waitcnt vmcnt(13)
    s_waitcnt lgkmcnt(12)
    v_mfma_f32_32x32x16_bf16 v[64:79], v[32:35], v[136:139], v[64:79]
    ds_read_b64_tr_b16 v[60:61], v27 offset:10240
    ds_read_b64_tr_b16 v[62:63], v27 offset:11264
    s_waitcnt lgkmcnt(12)
    v_mfma_f32_32x32x16_bf16 v[80:95], v[36:39], v[136:139], v[80:95]
    s_add_u32 s77, s78, s84
    s_add_u32 s84, s84, 2048
    s_and_b32 s84, s84, 0x7fff
    buffer_load_dwordx4 v[160:163], v8, s[60:63], s77 offen offset:0 sc1
    ds_read_b64_tr_b16 v[32:33], v24 offset:16384
    ds_read_b64_tr_b16 v[34:35], v24 offset:17408
    s_waitcnt lgkmcnt(12)
    v_mfma_f32_32x32x16_bf16 v[96:111], v[40:43], v[136:139], v[96:111]
    ds_read_b64_tr_b16 v[36:37], v25 offset:16384
    ds_read_b64_tr_b16 v[38:39], v25 offset:17408
    s_waitcnt lgkmcnt(12)
    v_mfma_f32_32x32x16_bf16 v[112:127], v[44:47], v[136:139], v[112:127]
    ds_read_b64_tr_b16 v[40:41], v26 offset:16384
    ds_read_b64_tr_b16 v[42:43], v26 offset:17408
    s_waitcnt vmcnt(5)
    s_waitcnt lgkmcnt(12)
    v_mfma_f32_32x32x16_bf16 v[64:79], v[48:51], v[140:143], v[64:79]
    ds_read_b64_tr_b16 v[44:45], v27 offset:16384
    ds_read_b64_tr_b16 v[46:47], v27 offset:17408
    s_waitcnt lgkmcnt(12)
    v_mfma_f32_32x32x16_bf16 v[80:95], v[52:55], v[140:143], v[80:95]
    buffer_load_dwordx4 v[164:167], v8, s[60:63], s77 offen offset:1024 sc1
    ds_read_b64_tr_b16 v[48:49], v24 offset:18432
    ds_read_b64_tr_b16 v[50:51], v24 offset:19456
    s_waitcnt lgkmcnt(12)
    v_mfma_f32_32x32x16_bf16 v[96:111], v[56:59], v[140:143], v[96:111]
    ds_read_b64_tr_b16 v[52:53], v25 offset:18432
    ds_read_b64_tr_b16 v[54:55], v25 offset:19456
    s_waitcnt lgkmcnt(12)
    v_mfma_f32_32x32x16_bf16 v[112:127], v[60:63], v[140:143], v[112:127]
    ds_read_b64_tr_b16 v[56:57], v26 offset:18432
    ds_read_b64_tr_b16 v[58:59], v26 offset:19456
    s_waitcnt vmcnt(5)
    s_waitcnt lgkmcnt(12)
    v_mfma_f32_32x32x16_bf16 v[64:79], v[32:35], v[144:147], v[64:79]
    ds_read_b64_tr_b16 v[60:61], v27 offset:18432
    ds_read_b64_tr_b16 v[62:63], v27 offset:19456
    v_add_f32 v240, v240, v242
    v_add_f32 v241, v241, v243
    v_add_f32 v244, v244, v246
    s_waitcnt lgkmcnt(12)
    v_mfma_f32_32x32x16_bf16 v[80:95], v[36:39], v[144:147], v[80:95]
    s_add_u32 s77, s78, s84
    s_add_u32 s84, s84, 2048
    s_and_b32 s84, s84, 0x7fff
    buffer_load_dwordx4 v[168:171], v8, s[60:63], s77 offen offset:0 sc1
    ds_read_b64_tr_b16 v[32:33], v24 offset:24576
    ds_read_b64_tr_b16 v[34:35], v24 offset:25600
    v_add_f32 v245, v245, v247
    v_add_f32 v248, v248, v250
    v_add_f32 v249, v249, v251
    s_waitcnt lgkmcnt(12)
    v_mfma_f32_32x32x16_bf16 v[96:111], v[40:43], v[144:147], v[96:111]
    ds_read_b64_tr_b16 v[36:37], v25 offset:24576
    ds_read_b64_tr_b16 v[38:39], v25 offset:25600
    v_add_f32 v252, v252, v254
    v_add_f32 v253, v253, v255
    v_add_f32 v240, v240, v244
    s_waitcnt lgkmcnt(12)
    v_mfma_f32_32x32x16_bf16 v[112:127], v[44:47], v[144:147], v[112:127]
    ds_read_b64_tr_b16 v[40:41], v26 offset:24576
    ds_read_b64_tr_b16 v[42:43], v26 offset:25600
    v_add_f32 v241, v241, v245
    v_add_f32 v248, v248, v252
    v_add_f32 v249, v249, v253
    s_waitcnt vmcnt(5)
    s_waitcnt lgkmcnt(12)
    v_mfma_f32_32x32x16_bf16 v[64:79], v[48:51], v[148:151], v[64:79]
    ds_read_b64_tr_b16 v[44:45], v27 offset:24576
    ds_read_b64_tr_b16 v[46:47], v27 offset:25600
    v_add_f32 v240, v240, v248
    v_add_f32 v241, v241, v249
    v_mov_b32 v242, v240
    s_waitcnt lgkmcnt(12)
    v_mfma_f32_32x32x16_bf16 v[80:95], v[52:55], v[148:151], v[80:95]
    buffer_load_dwordx4 v[172:175], v8, s[60:63], s77 offen offset:1024 sc1
    ds_read_b64_tr_b16 v[48:49], v24 offset:26624
    ds_read_b64_tr_b16 v[50:51], v24 offset:27648
    v_mov_b32 v243, v241
    s_mov_b32 s79, 0x3b000000
    s_nop 0
    s_waitcnt lgkmcnt(12)
    v_mfma_f32_32x32x16_bf16 v[96:111], v[56:59], v[148:151], v[96:111]
    ds_read_b64_tr_b16 v[52:53], v25 offset:26624
    ds_read_b64_tr_b16 v[54:55], v25 offset:27648
    v_permlane32_swap_b32 v240, v242
    v_permlane32_swap_b32 v241, v243
    v_add_f32 v240, v240, v242
    s_waitcnt lgkmcnt(12)
    v_mfma_f32_32x32x16_bf16 v[112:127], v[60:63], v[148:151], v[112:127]
    ds_read_b64_tr_b16 v[56:57], v26 offset:26624
    ds_read_b64_tr_b16 v[58:59], v26 offset:27648
    v_add_f32 v241, v241, v243
    v_mul_f32 v240, s79, v240
    v_mul_f32 v242, v240, v240
    s_waitcnt vmcnt(5)
    s_waitcnt lgkmcnt(12)
    v_mfma_f32_32x32x16_bf16 v[64:79], v[32:35], v[152:155], v[64:79]
    ds_read_b64_tr_b16 v[60:61], v27 offset:26624
    ds_read_b64_tr_b16 v[62:63], v27 offset:27648
    v_fma_f32 v241, v241, s79, -v242
    v_max_f32 v241, 0, v241
    v_add_f32 v241, 0x3727c5ac, v241
    s_waitcnt lgkmcnt(12)
    v_mfma_f32_32x32x16_bf16 v[80:95], v[36:39], v[152:155], v[80:95]
    s_add_u32 s77, s78, s84
    s_add_u32 s84, s84, 2048
    s_and_b32 s84, s84, 0x7fff
    buffer_load_dwordx4 v[176:179], v8, s[60:63], s77 offen offset:0 sc1
    ds_read_b64_tr_b16 v[32:33], v24 offset:32768
    ds_read_b64_tr_b16 v[34:35], v24 offset:33792
    v_sqrt_f32 v242, v241
    v_rcp_f32 v13, v241
    v_sub_f32 v240, 0, v240
    s_waitcnt lgkmcnt(12)
    v_mfma_f32_32x32x16_bf16 v[96:111], v[40:43], v[152:155], v[96:111]
    ds_read_b64_tr_b16 v[36:37], v25 offset:32768
    ds_read_b64_tr_b16 v[38:39], v25 offset:33792
    v_cvt_pk_bf16_f32 v28, v240, v240
    v_cvt_pk_bf16_f32 v30, v242, v242
    v_and_b32 v29, 0xffff0000, v28
    s_waitcnt lgkmcnt(12)
    v_mfma_f32_32x32x16_bf16 v[112:127], v[44:47], v[152:155], v[112:127]
    ds_read_b64_tr_b16 v[40:41], v26 offset:32768
    ds_read_b64_tr_b16 v[42:43], v26 offset:33792
    v_and_b32 v31, 0xffff0000, v30
    v_sub_f32 v29, v240, v29
    v_sub_f32 v31, v242, v31
    s_waitcnt vmcnt(5)
    s_waitcnt lgkmcnt(12)
    v_mfma_f32_32x32x16_bf16 v[64:79], v[48:51], v[156:159], v[64:79]
    ds_read_b64_tr_b16 v[44:45], v27 offset:32768
    ds_read_b64_tr_b16 v[46:47], v27 offset:33792
    v_cvt_pk_bf16_f32 v29, v29, v242
    v_cvt_pk_bf16_f32 v30, v242, v31
    v_mov_b32 v31, 0
    s_waitcnt lgkmcnt(12)
    v_mfma_f32_32x32x16_bf16 v[80:95], v[52:55], v[156:159], v[80:95]
    buffer_load_dwordx4 v[180:183], v8, s[60:63], s77 offen offset:1024 sc1
    ds_read_b64_tr_b16 v[48:49], v24 offset:34816
    ds_read_b64_tr_b16 v[50:51], v24 offset:35840
    v_cmp_gt_u32 vcc, 32, v1
    s_nop 0
    s_nop 0
    s_waitcnt lgkmcnt(12)
    v_mfma_f32_32x32x16_bf16 v[96:111], v[56:59], v[156:159], v[96:111]
    ds_read_b64_tr_b16 v[52:53], v25 offset:34816
    ds_read_b64_tr_b16 v[54:55], v25 offset:35840
    v_cndmask_b32 v28, 0, v28, vcc
    v_cndmask_b32 v29, 0, v29, vcc
    v_cndmask_b32 v30, 0, v30, vcc
    s_waitcnt lgkmcnt(12)
    v_mfma_f32_32x32x16_bf16 v[112:127], v[60:63], v[156:159], v[112:127]
    ds_read_b64_tr_b16 v[56:57], v26 offset:34816
    ds_read_b64_tr_b16 v[58:59], v26 offset:35840
    s_waitcnt vmcnt(5)
    s_waitcnt lgkmcnt(12)
    v_mfma_f32_32x32x16_bf16 v[64:79], v[32:35], v[160:163], v[64:79]
    s_barrier
    ds_read_b64_tr_b16 v[60:61], v27 offset:34816
    ds_read_b64_tr_b16 v[62:63], v27 offset:35840
    s_waitcnt lgkmcnt(12)
    v_mfma_f32_32x32x16_bf16 v[80:95], v[36:39], v[160:163], v[80:95]
    s_add_u32 s77, s78, s84
    s_add_u32 s84, s84, 2048
    s_and_b32 s84, s84, 0x7fff
    buffer_load_dwordx4 v[184:187], v8, s[60:63], s77 offen offset:0 sc1
    ds_read_b64_tr_b16 v[32:33], v24 offset:40960
    ds_read_b64_tr_b16 v[34:35], v24 offset:41984
    s_waitcnt lgkmcnt(12)
    v_mfma_f32_32x32x16_bf16 v[96:111], v[40:43], v[160:163], v[96:111]
    ds_read_b64_tr_b16 v[36:37], v25 offset:40960
    ds_read_b64_tr_b16 v[38:39], v25 offset:41984
    s_waitcnt lgkmcnt(12)
    v_mfma_f32_32x32x16_bf16 v[112:127], v[44:47], v[160:163], v[112:127]
    ds_read_b64_tr_b16 v[40:41], v26 offset:40960
    ds_read_b64_tr_b16 v[42:43], v26 offset:41984
    s_waitcnt vmcnt(5)
    s_waitcnt lgkmcnt(12)
    v_mfma_f32_32x32x16_bf16 v[64:79], v[48:51], v[164:167], v[64:79]
    ds_read_b64_tr_b16 v[44:45], v27 offset:40960
    ds_read_b64_tr_b16 v[46:47], v27 offset:41984
    s_waitcnt lgkmcnt(12)
    v_mfma_f32_32x32x16_bf16 v[80:95], v[52:55], v[164:167], v[80:95]
    buffer_load_dwordx4 v[188:191], v8, s[60:63], s77 offen offset:1024 sc1
    ds_read_b64_tr_b16 v[48:49], v24 offset:43008
    ds_read_b64_tr_b16 v[50:51], v24 offset:44032
    s_waitcnt lgkmcnt(12)
    v_mfma_f32_32x32x16_bf16 v[96:111], v[56:59], v[164:167], v[96:111]
    ds_read_b64_tr_b16 v[52:53], v25 offset:43008
    ds_read_b64_tr_b16 v[54:55], v25 offset:44032
    s_waitcnt lgkmcnt(12)
    v_mfma_f32_32x32x16_bf16 v[112:127], v[60:63], v[164:167], v[112:127]
    ds_read_b64_tr_b16 v[56:57], v26 offset:43008
    ds_read_b64_tr_b16 v[58:59], v26 offset:44032
    s_waitcnt vmcnt(5)
    s_waitcnt lgkmcnt(12)
    v_mfma_f32_32x32x16_bf16 v[64:79], v[32:35], v[168:171], v[64:79]
    ds_read_b64_tr_b16 v[60:61], v27 offset:43008
    ds_read_b64_tr_b16 v[62:63], v27 offset:44032
    s_waitcnt lgkmcnt(12)
    v_mfma_f32_32x32x16_bf16 v[80:95], v[36:39], v[168:171], v[80:95]
    s_add_u32 s77, s78, s84
    s_add_u32 s84, s84, 2048
    s_and_b32 s84, s84, 0x7fff
    buffer_load_dwordx4 v[192:195], v8, s[60:63], s77 offen offset:0 sc1
    ds_read_b64_tr_b16 v[32:33], v24 offset:49152
    ds_read_b64_tr_b16 v[34:35], v24 offset:50176
    s_waitcnt lgkmcnt(12)
    v_mfma_f32_32x32x16_bf16 v[96:111], v[40:43], v[168:171], v[96:111]
    ds_read_b64_tr_b16 v[36:37], v25 offset:49152
    ds_read_b64_tr_b16 v[38:39], v25 offset:50176
    s_waitcnt lgkmcnt(12)
    v_mfma_f32_32x32x16_bf16 v[112:127], v[44:47], v[168:171], v[112:127]
    ds_read_b64_tr_b16 v[40:41], v26 offset:49152
    ds_read_b64_tr_b16 v[42:43], v26 offset:50176
    s_waitcnt vmcnt(5)
    s_waitcnt lgkmcnt(12)
    v_mfma_f32_32x32x16_bf16 v[64:79], v[48:51], v[172:175], v[64:79]
    ds_read_b64_tr_b16 v[44:45], v27 offset:49152
    ds_read_b64_tr_b16 v[46:47], v27 offset:50176
    s_waitcnt lgkmcnt(12)
    v_mfma_f32_32x32x16_bf16 v[80:95], v[52:55], v[172:175], v[80:95]
    buffer_load_dwordx4 v[196:199], v8, s[60:63], s77 offen offset:1024 sc1
    ds_read_b64_tr_b16 v[48:49], v24 offset:51200
    ds_read_b64_tr_b16 v[50:51], v24 offset:52224
    s_waitcnt lgkmcnt(12)
    v_mfma_f32_32x32x16_bf16 v[96:111], v[56:59], v[172:175], v[96:111]
    ds_read_b64_tr_b16 v[52:53], v25 offset:51200
    ds_read_b64_tr_b16 v[54:55], v25 offset:52224
    s_waitcnt lgkmcnt(12)
    v_mfma_f32_32x32x16_bf16 v[112:127], v[60:63], v[172:175], v[112:127]
    ds_read_b64_tr_b16 v[56:57], v26 offset:51200
    ds_read_b64_tr_b16 v[58:59], v26 offset:52224
    s_waitcnt vmcnt(5)
    s_waitcnt lgkmcnt(12)
    v_mfma_f32_32x32x16_bf16 v[64:79], v[32:35], v[176:179], v[64:79]
    ds_read_b64_tr_b16 v[60:61], v27 offset:51200
    ds_read_b64_tr_b16 v[62:63], v27 offset:52224
    s_waitcnt lgkmcnt(12)
    v_mfma_f32_32x32x16_bf16 v[80:95], v[36:39], v[176:179], v[80:95]
    s_add_u32 s77, s78, s84
    s_add_u32 s84, s84, 2048
    s_and_b32 s84, s84, 0x7fff
    buffer_load_dwordx4 v[200:203], v8, s[60:63], s77 offen offset:0 sc1
    ds_read_b64_tr_b16 v[32:33], v24 offset:57344
    ds_read_b64_tr_b16 v[34:35], v24 offset:58368
    s_waitcnt lgkmcnt(12)
    v_mfma_f32_32x32x16_bf16 v[96:111], v[40:43], v[176:179], v[96:111]
    ds_read_b64_tr_b16 v[36:37], v25 offset:57344
    ds_read_b64_tr_b16 v[38:39], v25 offset:58368
    s_waitcnt lgkmcnt(12)
    v_mfma_f32_32x32x16_bf16 v[112:127], v[44:47], v[176:179], v[112:127]
    ds_read_b64_tr_b16 v[40:41], v26 offset:57344
    ds_read_b64_tr_b16 v[42:43], v26 offset:58368
    s_waitcnt vmcnt(5)
    s_waitcnt lgkmcnt(12)
    v_mfma_f32_32x32x16_bf16 v[64:79], v[48:51], v[180:183], v[64:79]
    ds_read_b64_tr_b16 v[44:45], v27 offset:57344
    ds_read_b64_tr_b16 v[46:47], v27 offset:58368
    s_waitcnt lgkmcnt(12)
    v_mfma_f32_32x32x16_bf16 v[80:95], v[52:55], v[180:183], v[80:95]
    buffer_load_dwordx4 v[204:207], v8, s[60:63], s77 offen offset:1024 sc1
    ds_read_b64_tr_b16 v[48:49], v24 offset:59392
    ds_read_b64_tr_b16 v[50:51], v24 offset:60416
    s_waitcnt lgkmcnt(12)
    v_mfma_f32_32x32x16_bf16 v[96:111], v[56:59], v[180:183], v[96:111]
    ds_read_b64_tr_b16 v[52:53], v25 offset:59392
    ds_read_b64_tr_b16 v[54:55], v25 offset:60416
    s_waitcnt lgkmcnt(12)
    v_mfma_f32_32x32x16_bf16 v[112:127], v[60:63], v[180:183], v[112:127]
    ds_read_b64_tr_b16 v[56:57], v26 offset:59392
    ds_read_b64_tr_b16 v[58:59], v26 offset:60416
    s_waitcnt vmcnt(5)
    s_waitcnt lgkmcnt(12)
    v_mfma_f32_32x32x16_bf16 v[64:79], v[32:35], v[184:187], v[64:79]
    ds_read_b64_tr_b16 v[60:61], v27 offset:59392
    ds_read_b64_tr_b16 v[62:63], v27 offset:60416
    s_waitcnt lgkmcnt(12)
    v_mfma_f32_32x32x16_bf16 v[80:95], v[36:39], v[184:187], v[80:95]
    s_add_u32 s77, s78, s84
    s_add_u32 s84, s84, 2048
    s_and_b32 s84, s84, 0x7fff
    buffer_load_dwordx4 v[208:211], v8, s[60:63], s77 offen offset:0 sc1
    v_add_u32 v24, 65536, v24
    ds_read_b64_tr_b16 v[32:33], v24 offset:0
    ds_read_b64_tr_b16 v[34:35], v24 offset:1024
    s_waitcnt lgkmcnt(12)
    v_mfma_f32_32x32x16_bf16 v[96:111], v[40:43], v[184:187], v[96:111]
    v_add_u32 v25, 65536, v25
    ds_read_b64_tr_b16 v[36:37], v25 offset:0
    ds_read_b64_tr_b16 v[38:39], v25 offset:1024
    s_waitcnt lgkmcnt(12)
    v_mfma_f32_32x32x16_bf16 v[112:127], v[44:47], v[184:187], v[112:127]
    v_add_u32 v26, 65536, v26
    ds_read_b64_tr_b16 v[40:41], v26 offset:0
    ds_read_b64_tr_b16 v[42:43], v26 offset:1024
    s_waitcnt vmcnt(5)
    s_waitcnt lgkmcnt(12)
    v_mfma_f32_32x32x16_bf16 v[64:79], v[48:51], v[188:191], v[64:79]
    v_add_u32 v27, 65536, v27
    ds_read_b64_tr_b16 v[44:45], v27 offset:0
    ds_read_b64_tr_b16 v[46:47], v27 offset:1024
    s_waitcnt lgkmcnt(12)
    v_mfma_f32_32x32x16_bf16 v[80:95], v[52:55], v[188:191], v[80:95]
    buffer_load_dwordx4 v[212:215], v8, s[60:63], s77 offen offset:1024 sc1
    ds_read_b64_tr_b16 v[48:49], v24 offset:2048
    ds_read_b64_tr_b16 v[50:51], v24 offset:3072
    s_waitcnt lgkmcnt(12)
    v_mfma_f32_32x32x16_bf16 v[96:111], v[56:59], v[188:191], v[96:111]
    ds_read_b64_tr_b16 v[52:53], v25 offset:2048
    ds_read_b64_tr_b16 v[54:55], v25 offset:3072
    s_waitcnt lgkmcnt(12)
    v_mfma_f32_32x32x16_bf16 v[112:127], v[60:63], v[188:191], v[112:127]
    ds_read_b64_tr_b16 v[56:57], v26 offset:2048
    ds_read_b64_tr_b16 v[58:59], v26 offset:3072
    s_waitcnt vmcnt(5)
    s_waitcnt lgkmcnt(12)
    v_mfma_f32_32x32x16_bf16 v[64:79], v[32:35], v[192:195], v[64:79]
    s_barrier
    ds_read_b64_tr_b16 v[60:61], v27 offset:2048
    ds_read_b64_tr_b16 v[62:63], v27 offset:3072
    s_waitcnt lgkmcnt(12)
    v_mfma_f32_32x32x16_bf16 v[80:95], v[36:39], v[192:195], v[80:95]
    s_add_u32 s77, s78, s84
    s_add_u32 s84, s84, 2048
    s_and_b32 s84, s84, 0x7fff
    buffer_load_dwordx4 v[216:219], v8, s[60:63], s77 offen offset:0 sc1
    v_subrev_u32 v24, 131072, v24
    ds_read_b64_tr_b16 v[32:33], v24 offset:0
    ds_read_b64_tr_b16 v[34:35], v24 offset:1024
    s_waitcnt lgkmcnt(12)
    v_mfma_f32_32x32x16_bf16 v[96:111], v[40:43], v[192:195], v[96:111]
    v_subrev_u32 v25, 131072, v25
    ds_read_b64_tr_b16 v[36:37], v25 offset:0
    ds_read_b64_tr_b16 v[38:39], v25 offset:1024
    s_waitcnt lgkmcnt(12)
    v_mfma_f32_32x32x16_bf16 v[112:127], v[44:47], v[192:195], v[112:127]
    v_subrev_u32 v26, 131072, v26
    ds_read_b64_tr_b16 v[40:41], v26 offset:0
    ds_read_b64_tr_b16 v[42:43], v26 offset:1024
    s_waitcnt vmcnt(5)
    s_waitcnt lgkmcnt(12)
    v_mfma_f32_32x32x16_bf16 v[64:79], v[48:51], v[196:199], v[64:79]
    v_subrev_u32 v27, 131072, v27
    ds_read_b64_tr_b16 v[44:45], v27 offset:0
    ds_read_b64_tr_b16 v[46:47], v27 offset:1024
    s_waitcnt lgkmcnt(12)
    v_mfma_f32_32x32x16_bf16 v[80:95], v[52:55], v[196:199], v[80:95]
    buffer_load_dwordx4 v[220:223], v8, s[60:63], s77 offen offset:1024 sc1
    ds_read_b64_tr_b16 v[48:49], v24 offset:2048
    ds_read_b64_tr_b16 v[50:51], v24 offset:3072
    s_waitcnt lgkmcnt(12)
    v_mfma_f32_32x32x16_bf16 v[96:111], v[56:59], v[196:199], v[96:111]
    ds_read_b64_tr_b16 v[52:53], v25 offset:2048
    ds_read_b64_tr_b16 v[54:55], v25 offset:3072
    s_waitcnt lgkmcnt(12)
    v_mfma_f32_32x32x16_bf16 v[112:127], v[60:63], v[196:199], v[112:127]
    ds_read_b64_tr_b16 v[56:57], v26 offset:2048
    ds_read_b64_tr_b16 v[58:59], v26 offset:3072
    s_waitcnt vmcnt(5)
    s_waitcnt lgkmcnt(12)
    v_mfma_f32_32x32x16_bf16 v[64:79], v[32:35], v[200:203], v[64:79]
    ds_read_b64_tr_b16 v[60:61], v27 offset:2048
    ds_read_b64_tr_b16 v[62:63], v27 offset:3072
    s_waitcnt lgkmcnt(12)
    v_mfma_f32_32x32x16_bf16 v[80:95], v[36:39], v[200:203], v[80:95]
    s_add_u32 s77, s78, s84
    s_add_u32 s84, s84, 2048
    s_and_b32 s84, s84, 0x7fff
    buffer_load_dwordx4 v[224:227], v8, s[60:63], s77 offen offset:0 sc1
    ds_read_b64_tr_b16 v[32:33], v24 offset:8192
    ds_read_b64_tr_b16 v[34:35], v24 offset:9216
    s_waitcnt lgkmcnt(12)
    v_mfma_f32_32x32x16_bf16 v[96:111], v[40:43], v[200:203], v[96:111]
    ds_read_b64_tr_b16 v[36:37], v25 offset:8192
    ds_read_b64_tr_b16 v[38:39], v25 offset:9216
    s_waitcnt lgkmcnt(12)
    v_mfma_f32_32x32x16_bf16 v[112:127], v[44:47], v[200:203], v[112:127]
    ds_read_b64_tr_b16 v[40:41], v26 offset:8192
    ds_read_b64_tr_b16 v[42:43], v26 offset:9216
    s_waitcnt vmcnt(5)
    s_waitcnt lgkmcnt(12)
    v_mfma_f32_32x32x16_bf16 v[64:79], v[48:51], v[204:207], v[64:79]
    ds_read_b64_tr_b16 v[44:45], v27 offset:8192
    ds_read_b64_tr_b16 v[46:47], v27 offset:9216
    s_waitcnt lgkmcnt(12)
    v_mfma_f32_32x32x16_bf16 v[80:95], v[52:55], v[204:207], v[80:95]
    buffer_load_dwordx4 v[228:231], v8, s[60:63], s77 offen offset:1024 sc1
    ds_read_b64_tr_b16 v[48:49], v24 offset:10240
    ds_read_b64_tr_b16 v[50:51], v24 offset:11264
    s_waitcnt lgkmcnt(12)
    v_mfma_f32_32x32x16_bf16 v[96:111], v[56:59], v[204:207], v[96:111]
    ds_read_b64_tr_b16 v[52:53], v25 offset:10240
    ds_read_b64_tr_b16 v[54:55], v25 offset:11264
    s_waitcnt lgkmcnt(12)
    v_mfma_f32_32x32x16_bf16 v[112:127], v[60:63], v[204:207], v[112:127]
    ds_read_b64_tr_b16 v[56:57], v26 offset:10240
    ds_read_b64_tr_b16 v[58:59], v26 offset:11264
    s_waitcnt vmcnt(5)
    s_waitcnt lgkmcnt(12)
    v_mfma_f32_32x32x16_bf16 v[64:79], v[32:35], v[208:211], v[64:79]
    ds_read_b64_tr_b16 v[60:61], v27 offset:10240
    ds_read_b64_tr_b16 v[62:63], v27 offset:11264
    s_waitcnt lgkmcnt(12)
    v_mfma_f32_32x32x16_bf16 v[80:95], v[36:39], v[208:211], v[80:95]
    s_add_u32 s77, s78, s84
    s_add_u32 s84, s84, 2048
    s_and_b32 s84, s84, 0x7fff
    buffer_load_dwordx4 v[232:235], v8, s[60:63], s77 offen offset:0 sc1
    ds_read_b64_tr_b16 v[32:33], v24 offset:16384
    ds_read_b64_tr_b16 v[34:35], v24 offset:17408
    s_waitcnt lgkmcnt(12)
    v_mfma_f32_32x32x16_bf16 v[96:111], v[40:43], v[208:211], v[96:111]
    ds_read_b64_tr_b16 v[36:37], v25 offset:16384
    ds_read_b64_tr_b16 v[38:39], v25 offset:17408
    s_waitcnt lgkmcnt(12)
    v_mfma_f32_32x32x16_bf16 v[112:127], v[44:47], v[208:211], v[112:127]
    ds_read_b64_tr_b16 v[40:41], v26 offset:16384
    ds_read_b64_tr_b16 v[42:43], v26 offset:17408
    s_waitcnt vmcnt(5)
    s_waitcnt lgkmcnt(12)
    v_mfma_f32_32x32x16_bf16 v[64:79], v[48:51], v[212:215], v[64:79]
    ds_read_b64_tr_b16 v[44:45], v27 offset:16384
    ds_read_b64_tr_b16 v[46:47], v27 offset:17408
    s_waitcnt lgkmcnt(12)
    v_mfma_f32_32x32x16_bf16 v[80:95], v[52:55], v[212:215], v[80:95]
    buffer_load_dwordx4 v[236:239], v8, s[60:63], s77 offen offset:1024 sc1
    ds_read_b64_tr_b16 v[48:49], v24 offset:18432
    ds_read_b64_tr_b16 v[50:51], v24 offset:19456
    s_waitcnt lgkmcnt(12)
    v_mfma_f32_32x32x16_bf16 v[96:111], v[56:59], v[212:215], v[96:111]
    ds_read_b64_tr_b16 v[52:53], v25 offset:18432
    ds_read_b64_tr_b16 v[54:55], v25 offset:19456
    s_waitcnt lgkmcnt(12)
    v_mfma_f32_32x32x16_bf16 v[112:127], v[60:63], v[212:215], v[112:127]
    ds_read_b64_tr_b16 v[56:57], v26 offset:18432
    ds_read_b64_tr_b16 v[58:59], v26 offset:19456
    s_waitcnt vmcnt(5)
    s_waitcnt lgkmcnt(12)
    v_mfma_f32_32x32x16_bf16 v[64:79], v[32:35], v[216:219], v[64:79]
    ds_read_b64_tr_b16 v[60:61], v27 offset:18432
    ds_read_b64_tr_b16 v[62:63], v27 offset:19456
    s_waitcnt lgkmcnt(12)
    v_mfma_f32_32x32x16_bf16 v[80:95], v[36:39], v[216:219], v[80:95]
    s_add_u32 s77, s78, s84
    s_add_u32 s84, s84, 2048
    s_and_b32 s84, s84, 0x7fff
    buffer_load_dwordx4 v[240:243], v8, s[60:63], s77 offen offset:0 sc1
    ds_read_b64_tr_b16 v[32:33], v24 offset:24576
    ds_read_b64_tr_b16 v[34:35], v24 offset:25600
    s_waitcnt lgkmcnt(12)
    v_mfma_f32_32x32x16_bf16 v[96:111], v[40:43], v[216:219], v[96:111]
    ds_read_b64_tr_b16 v[36:37], v25 offset:24576
    ds_read_b64_tr_b16 v[38:39], v25 offset:25600
    s_waitcnt lgkmcnt(12)
    v_mfma_f32_32x32x16_bf16 v[112:127], v[44:47], v[216:219], v[112:127]
    ds_read_b64_tr_b16 v[40:41], v26 offset:24576
    ds_read_b64_tr_b16 v[42:43], v26 offset:25600
    s_waitcnt vmcnt(5)
    s_waitcnt lgkmcnt(12)
    v_mfma_f32_32x32x16_bf16 v[64:79], v[48:51], v[220:223], v[64:79]
    ds_read_b64_tr_b16 v[44:45], v27 offset:24576
    ds_read_b64_tr_b16 v[46:47], v27 offset:25600
    s_waitcnt lgkmcnt(12)
    v_mfma_f32_32x32x16_bf16 v[80:95], v[52:55], v[220:223], v[80:95]
    buffer_load_dwordx4 v[244:247], v8, s[60:63], s77 offen offset:1024 sc1
    ds_read_b64_tr_b16 v[48:49], v24 offset:26624
    ds_read_b64_tr_b16 v[50:51], v24 offset:27648
    s_waitcnt lgkmcnt(12)
    v_mfma_f32_32x32x16_bf16 v[96:111], v[56:59], v[220:223], v[96:111]
    ds_read_b64_tr_b16 v[52:53], v25 offset:26624
    ds_read_b64_tr_b16 v[54:55], v25 offset:27648
    s_waitcnt lgkmcnt(12)
    v_mfma_f32_32x32x16_bf16 v[112:127], v[60:63], v[220:223], v[112:127]
    ds_read_b64_tr_b16 v[56:57], v26 offset:26624
    ds_read_b64_tr_b16 v[58:59], v26 offset:27648
    s_waitcnt vmcnt(5)
    s_waitcnt lgkmcnt(12)
    v_mfma_f32_32x32x16_bf16 v[64:79], v[32:35], v[224:227], v[64:79]
    s_barrier
    ds_read_b64_tr_b16 v[60:61], v27 offset:26624
    ds_read_b64_tr_b16 v[62:63], v27 offset:27648
    s_waitcnt lgkmcnt(12)
    v_mfma_f32_32x32x16_bf16 v[80:95], v[36:39], v[224:227], v[80:95]
    s_add_u32 s77, s78, s84
    s_add_u32 s84, s84, 2048
    s_and_b32 s84, s84, 0x7fff
    buffer_load_dwordx4 v[248:251], v8, s[60:63], s77 offen offset:0 sc1
    ds_read_b64_tr_b16 v[32:33], v24 offset:32768
    ds_read_b64_tr_b16 v[34:35], v24 offset:33792
    s_waitcnt lgkmcnt(12)
    v_mfma_f32_32x32x16_bf16 v[96:111], v[40:43], v[224:227], v[96:111]
    ds_read_b64_tr_b16 v[36:37], v24 offset:34816
    ds_read_b64_tr_b16 v[38:39], v24 offset:35840
    s_waitcnt lgkmcnt(12)
    v_mfma_f32_32x32x16_bf16 v[112:127], v[44:47], v[224:227], v[112:127]
    ds_read_b64_tr_b16 v[40:41], v24 offset:40960
    ds_read_b64_tr_b16 v[42:43], v24 offset:41984
    s_waitcnt vmcnt(5)
    s_waitcnt lgkmcnt(12)
    v_mfma_f32_32x32x16_bf16 v[64:79], v[48:51], v[228:231], v[64:79]
    ds_read_b64_tr_b16 v[44:45], v24 offset:43008
    ds_read_b64_tr_b16 v[46:47], v24 offset:44032
    s_waitcnt lgkmcnt(12)
    v_mfma_f32_32x32x16_bf16 v[80:95], v[52:55], v[228:231], v[80:95]
    buffer_load_dwordx4 v[252:255], v8, s[60:63], s77 offen offset:1024 sc1
    ds_read_b64_tr_b16 v[48:49], v24 offset:49152
    ds_read_b64_tr_b16 v[50:51], v24 offset:50176
    s_waitcnt lgkmcnt(12)
    v_mfma_f32_32x32x16_bf16 v[96:111], v[56:59], v[228:231], v[96:111]
    ds_read_b64_tr_b16 v[52:53], v24 offset:51200
    ds_read_b64_tr_b16 v[54:55], v24 offset:52224
    s_waitcnt lgkmcnt(12)
    v_mfma_f32_32x32x16_bf16 v[112:127], v[60:63], v[228:231], v[112:127]
    ds_read_b128 v[56:59], v10 offset:2048
    s_waitcnt vmcnt(5)
    s_waitcnt lgkmcnt(11)
    v_mfma_f32_32x32x16_bf16 v[64:79], v[32:35], v[232:235], v[64:79]
    ds_read_b64_tr_b16 v[60:61], v25 offset:32768
    ds_read_b64_tr_b16 v[62:63], v25 offset:33792
    s_waitcnt vmcnt(4)
    s_waitcnt lgkmcnt(11)
    v_mfma_f32_32x32x16_bf16 v[64:79], v[36:39], v[236:239], v[64:79]
    ds_read_b64_tr_b16 v[32:33], v25 offset:34816
    ds_read_b64_tr_b16 v[34:35], v25 offset:35840
    s_waitcnt vmcnt(3)
    s_waitcnt lgkmcnt(11)
    v_mfma_f32_32x32x16_bf16 v[64:79], v[40:43], v[240:243], v[64:79]
    ds_read_b64_tr_b16 v[36:37], v25 offset:40960
    ds_read_b64_tr_b16 v[38:39], v25 offset:41984
    s_waitcnt vmcnt(2)
    s_waitcnt lgkmcnt(11)
    v_mfma_f32_32x32x16_bf16 v[64:79], v[44:47], v[244:247], v[64:79]
    ds_read_b64_tr_b16 v[40:41], v25 offset:43008
    ds_read_b64_tr_b16 v[42:43], v25 offset:44032
    s_waitcnt vmcnt(1)
    s_waitcnt lgkmcnt(11)
    v_mfma_f32_32x32x16_bf16 v[64:79], v[48:51], v[248:251], v[64:79]
    ds_read_b64_tr_b16 v[44:45], v25 offset:49152
    ds_read_b64_tr_b16 v[46:47], v25 offset:50176
    s_waitcnt vmcnt(0)
    s_waitcnt lgkmcnt(11)
    v_mfma_f32_32x32x16_bf16 v[64:79], v[52:55], v[252:255], v[64:79]
    ds_read_b64_tr_b16 v[48:49], v25 offset:51200
    ds_read_b64_tr_b16 v[50:51], v25 offset:52224
    s_waitcnt lgkmcnt(12)
    v_mfma_f32_32x32x16_bf16 v[64:79], v[56:59], v[28:31], v[64:79]
    s_add_u32 s85, s90, 0
    ds_read_b128 v[52:55], v10 offset:2560
    s_waitcnt lgkmcnt(11)
    v_mfma_f32_32x32x16_bf16 v[80:95], v[60:63], v[232:235], v[80:95]
    ds_read_b64_tr_b16 v[56:57], v26 offset:32768
    ds_read_b64_tr_b16 v[58:59], v26 offset:33792
    s_waitcnt lgkmcnt(11)
    v_mfma_f32_32x32x16_bf16 v[80:95], v[32:35], v[236:239], v[80:95]
    ds_read_b64_tr_b16 v[60:61], v26 offset:34816
    ds_read_b64_tr_b16 v[62:63], v26 offset:35840
    s_waitcnt lgkmcnt(11)
    v_mfma_f32_32x32x16_bf16 v[80:95], v[36:39], v[240:243], v[80:95]
    ds_read_b64_tr_b16 v[32:33], v26 offset:40960
    ds_read_b64_tr_b16 v[34:35], v26 offset:41984
    v_mul_f32 v64, v64, v72
    v_mul_f32 v65, v65, v73
    v_mul_f32 v66, v66, v74
    v_mul_f32 v67, v67, v75
    s_waitcnt lgkmcnt(11)
    v_mfma_f32_32x32x16_bf16 v[80:95], v[40:43], v[244:247], v[80:95]
    ds_read_b64_tr_b16 v[36:37], v26 offset:43008
    ds_read_b64_tr_b16 v[38:39], v26 offset:44032
    v_mul_f32 v68, v68, v76
    v_mul_f32 v69, v69, v77
    v_mul_f32 v70, v70, v78
    v_mul_f32 v71, v71, v79
    s_waitcnt lgkmcnt(11)
    v_mfma_f32_32x32x16_bf16 v[80:95], v[44:47], v[248:251], v[80:95]
    ds_read_b64_tr_b16 v[40:41], v26 offset:49152
    ds_read_b64_tr_b16 v[42:43], v26 offset:50176
    v_mul_f32 v64, v64, v13
    v_mul_f32 v65, v65, v13
    v_mul_f32 v66, v66, v13
    v_mul_f32 v67, v67, v13
    s_waitcnt lgkmcnt(11)
    v_mfma_f32_32x32x16_bf16 v[80:95], v[48:51], v[252:255], v[80:95]
    ds_read_b64_tr_b16 v[44:45], v26 offset:51200
    ds_read_b64_tr_b16 v[46:47], v26 offset:52224
    v_mul_f32 v68, v68, v13
    v_mul_f32 v69, v69, v13
    v_mul_f32 v70, v70, v13
    v_mul_f32 v71, v71, v13
    s_waitcnt lgkmcnt(12)
    v_mfma_f32_32x32x16_bf16 v[80:95], v[52:55], v[28:31], v[80:95]
    ds_read_b128 v[48:51], v10 offset:3072
    v_cvt_pk_bf16_f32 v72, v64, v65
    v_cvt_pk_bf16_f32 v73, v66, v67
    v_cvt_pk_bf16_f32 v74, v68, v69
    v_cvt_pk_bf16_f32 v75, v70, v71
    s_waitcnt lgkmcnt(11)
    v_mfma_f32_32x32x16_bf16 v[96:111], v[56:59], v[232:235], v[96:111]
    ds_read_b64_tr_b16 v[52:53], v27 offset:32768
    ds_read_b64_tr_b16 v[54:55], v27 offset:33792
    buffer_store_dwordx4 v[72:75], v8, s[60:63], s85 offen offset:0 sc1
    s_waitcnt lgkmcnt(11)
    v_mfma_f32_32x32x16_bf16 v[96:111], v[60:63], v[236:239], v[96:111]
    ds_read_b64_tr_b16 v[56:57], v27 offset:34816
    ds_read_b64_tr_b16 v[58:59], v27 offset:35840
    v_mul_f32 v80, v80, v88
    v_mul_f32 v81, v81, v89
    v_mul_f32 v82, v82, v90
    v_mul_f32 v83, v83, v91
    s_waitcnt lgkmcnt(11)
    v_mfma_f32_32x32x16_bf16 v[96:111], v[32:35], v[240:243], v[96:111]
    ds_read_b64_tr_b16 v[60:61], v27 offset:40960
    ds_read_b64_tr_b16 v[62:63], v27 offset:41984
    v_mul_f32 v84, v84, v92
    v_mul_f32 v85, v85, v93
    v_mul_f32 v86, v86, v94
    v_mul_f32 v87, v87, v95
    s_waitcnt lgkmcnt(11)
    v_mfma_f32_32x32x16_bf16 v[96:111], v[36:39], v[244:247], v[96:111]
    ds_read_b64_tr_b16 v[32:33], v27 offset:43008
    ds_read_b64_tr_b16 v[34:35], v27 offset:44032
    v_mul_f32 v80, v80, v13
    v_mul_f32 v81, v81, v13
    v_mul_f32 v82, v82, v13
    v_mul_f32 v83, v83, v13
    s_waitcnt lgkmcnt(11)
    v_mfma_f32_32x32x16_bf16 v[96:111], v[40:43], v[248:251], v[96:111]
    ds_read_b64_tr_b16 v[36:37], v27 offset:49152
    ds_read_b64_tr_b16 v[38:39], v27 offset:50176
    v_mul_f32 v84, v84, v13
    v_mul_f32 v85, v85, v13
    v_mul_f32 v86, v86, v13
    v_mul_f32 v87, v87, v13
    s_waitcnt lgkmcnt(11)
    v_mfma_f32_32x32x16_bf16 v[96:111], v[44:47], v[252:255], v[96:111]
    ds_read_b64_tr_b16 v[40:41], v27 offset:51200
    ds_read_b64_tr_b16 v[42:43], v27 offset:52224
    v_cvt_pk_bf16_f32 v88, v80, v81
    v_cvt_pk_bf16_f32 v89, v82, v83
    v_cvt_pk_bf16_f32 v90, v84, v85
    v_cvt_pk_bf16_f32 v91, v86, v87
    s_waitcnt lgkmcnt(12)
    v_mfma_f32_32x32x16_bf16 v[96:111], v[48:51], v[28:31], v[96:111]
    ds_read_b128 v[44:47], v10 offset:3584
    buffer_store_dwordx4 v[88:91], v8, s[60:63], s85 offen offset:1024 sc1
    s_waitcnt lgkmcnt(11)
    v_mfma_f32_32x32x16_bf16 v[112:127], v[52:55], v[232:235], v[112:127]
    ds_read_b64_tr_b16 v[48:49], v24 offset:57344
    ds_read_b64_tr_b16 v[50:51], v24 offset:58368
    s_waitcnt lgkmcnt(11)
    v_mfma_f32_32x32x16_bf16 v[112:127], v[56:59], v[236:239], v[112:127]
    ds_read_b64_tr_b16 v[52:53], v25 offset:57344
    ds_read_b64_tr_b16 v[54:55], v25 offset:58368
    s_waitcnt lgkmcnt(11)
    v_mfma_f32_32x32x16_bf16 v[112:127], v[60:63], v[240:243], v[112:127]
    ds_read_b64_tr_b16 v[56:57], v26 offset:57344
    ds_read_b64_tr_b16 v[58:59], v26 offset:58368
    v_mul_f32 v96, v96, v104
    v_mul_f32 v97, v97, v105
    v_mul_f32 v98, v98, v106
    v_mul_f32 v99, v99, v107
    s_waitcnt lgkmcnt(11)
    v_mfma_f32_32x32x16_bf16 v[112:127], v[32:35], v[244:247], v[112:127]
    ds_read_b64_tr_b16 v[60:61], v24 offset:59392
    ds_read_b64_tr_b16 v[62:63], v24 offset:60416
    v_mul_f32 v100, v100, v108
    v_mul_f32 v101, v101, v109
    v_mul_f32 v102, v102, v110
    v_mul_f32 v103, v103, v111
    s_waitcnt lgkmcnt(11)
    v_mfma_f32_32x32x16_bf16 v[112:127], v[36:39], v[248:251], v[112:127]
    ds_read_b64_tr_b16 v[32:33], v25 offset:59392
    ds_read_b64_tr_b16 v[34:35], v25 offset:60416
    v_mul_f32 v96, v96, v13
    v_mul_f32 v97, v97, v13
    v_mul_f32 v98, v98, v13
    v_mul_f32 v99, v99, v13
    s_waitcnt lgkmcnt(11)
    v_mfma_f32_32x32x16_bf16 v[112:127], v[40:43], v[252:255], v[112:127]
    ds_read_b64_tr_b16 v[36:37], v26 offset:59392
    ds_read_b64_tr_b16 v[38:39], v26 offset:60416
    v_mul_f32 v100, v100, v13
    v_mul_f32 v101, v101, v13
    v_mul_f32 v102, v102, v13
    v_mul_f32 v103, v103, v13
    s_waitcnt lgkmcnt(12)
    v_mfma_f32_32x32x16_bf16 v[112:127], v[44:47], v[28:31], v[112:127]
    v_add_u32 v24, 131072, v24
    ds_read_b64_tr_b16 v[40:41], v24 offset:8192
    ds_read_b64_tr_b16 v[42:43], v24 offset:9216
    v_cvt_pk_bf16_f32 v104, v96, v97
    v_cvt_pk_bf16_f32 v105, v98, v99
    v_cvt_pk_bf16_f32 v106, v100, v101
    v_cvt_pk_bf16_f32 v107, v102, v103
    s_waitcnt lgkmcnt(12)
    v_mfma_f32_32x32x16_bf16 v[64:79], v[48:51], v[128:131], 0
    v_add_u32 v25, 131072, v25
    ds_read_b64_tr_b16 v[44:45], v25 offset:8192
    ds_read_b64_tr_b16 v[46:47], v25 offset:9216
    buffer_store_dwordx4 v[104:107], v8, s[60:63], s85 offen offset:2048 sc1
    v_mul_f32 v112, v112, v120
    v_mul_f32 v113, v113, v121
    v_mul_f32 v114, v114, v122
    s_waitcnt lgkmcnt(12)
    v_mfma_f32_32x32x16_bf16 v[80:95], v[52:55], v[128:131], 0
    v_add_u32 v26, 131072, v26
    ds_read_b64_tr_b16 v[48:49], v26 offset:8192
    ds_read_b64_tr_b16 v[50:51], v26 offset:9216
    v_mul_f32 v115, v115, v123
    v_mul_f32 v116, v116, v124
    v_mul_f32 v117, v117, v125
    v_mul_f32 v118, v118, v126
    s_waitcnt lgkmcnt(12)
    v_mfma_f32_32x32x16_bf16 v[96:111], v[56:59], v[128:131], 0
    ds_read_b64_tr_b16 v[52:53], v27 offset:57344
    ds_read_b64_tr_b16 v[54:55], v27 offset:58368
    v_mul_f32 v119, v119, v127
    v_mul_f32 v112, v112, v13
    v_mul_f32 v113, v113, v13
    v_mul_f32 v114, v114, v13
    s_waitcnt lgkmcnt(12)
    v_mfma_f32_32x32x16_bf16 v[64:79], v[60:63], v[132:135], v[64:79]
    ds_read_b64_tr_b16 v[56:57], v27 offset:59392
    ds_read_b64_tr_b16 v[58:59], v27 offset:60416
    v_mul_f32 v115, v115, v13
    v_mul_f32 v116, v116, v13
    v_mul_f32 v117, v117, v13
    v_mul_f32 v118, v118, v13
    s_waitcnt lgkmcnt(12)
    v_mfma_f32_32x32x16_bf16 v[80:95], v[32:35], v[132:135], v[80:95]
    v_add_u32 v27, 131072, v27
    ds_read_b64_tr_b16 v[60:61], v27 offset:8192
    ds_read_b64_tr_b16 v[62:63], v27 offset:9216
    v_mul_f32 v119, v119, v13
    v_cvt_pk_bf16_f32 v120, v112, v113
    v_cvt_pk_bf16_f32 v121, v114, v115
    v_cvt_pk_bf16_f32 v122, v116, v117
    s_waitcnt lgkmcnt(12)
    v_mfma_f32_32x32x16_bf16 v[96:111], v[36:39], v[132:135], v[96:111]
    ds_read_b64_tr_b16 v[32:33], v24 offset:10240
    ds_read_b64_tr_b16 v[34:35], v24 offset:11264
    v_cvt_pk_bf16_f32 v123, v118, v119
    buffer_store_dwordx4 v[120:123], v8, s[60:63], s85 offen offset:3072 sc1
    s_waitcnt lgkmcnt(12)
    v_mfma_f32_32x32x16_bf16 v[64:79], v[40:43], v[136:139], v[64:79]
    ds_read_b64_tr_b16 v[36:37], v25 offset:10240
    ds_read_b64_tr_b16 v[38:39], v25 offset:11264
    s_waitcnt lgkmcnt(12)
    v_mfma_f32_32x32x16_bf16 v[80:95], v[44:47], v[136:139], v[80:95]
    ds_read_b64_tr_b16 v[40:41], v26 offset:10240
    ds_read_b64_tr_b16 v[42:43], v26 offset:11264
    s_waitcnt lgkmcnt(12)
    v_mfma_f32_32x32x16_bf16 v[96:111], v[48:51], v[136:139], v[96:111]
    ds_read_b64_tr_b16 v[44:45], v27 offset:10240
    ds_read_b64_tr_b16 v[46:47], v27 offset:11264
    s_waitcnt lgkmcnt(12)
    v_mfma_f32_32x32x16_bf16 v[112:127], v[52:55], v[128:131], 0
    ds_read_b64_tr_b16 v[48:49], v24 offset:16384
    ds_read_b64_tr_b16 v[50:51], v24 offset:17408
    s_waitcnt lgkmcnt(12)
    v_mfma_f32_32x32x16_bf16 v[112:127], v[56:59], v[132:135], v[112:127]
    ds_read_b64_tr_b16 v[52:53], v25 offset:16384
    ds_read_b64_tr_b16 v[54:55], v25 offset:17408
    s_waitcnt lgkmcnt(12)
    v_mfma_f32_32x32x16_bf16 v[112:127], v[60:63], v[136:139], v[112:127]
    ds_read_b64_tr_b16 v[56:57], v26 offset:16384
    ds_read_b64_tr_b16 v[58:59], v26 offset:17408
    s_waitcnt lgkmcnt(12)
    v_mfma_f32_32x32x16_bf16 v[64:79], v[32:35], v[140:143], v[64:79]
    s_barrier
    ds_read_b64_tr_b16 v[60:61], v27 offset:16384
    ds_read_b64_tr_b16 v[62:63], v27 offset:17408
    s_waitcnt lgkmcnt(12)
    v_mfma_f32_32x32x16_bf16 v[80:95], v[36:39], v[140:143], v[80:95]
    ds_read_b64_tr_b16 v[32:33], v24 offset:18432
    ds_read_b64_tr_b16 v[34:35], v24 offset:19456
    s_waitcnt lgkmcnt(12)
    v_mfma_f32_32x32x16_bf16 v[96:111], v[40:43], v[140:143], v[96:111]
    ds_read_b64_tr_b16 v[36:37], v25 offset:18432
    ds_read_b64_tr_b16 v[38:39], v25 offset:19456
    s_waitcnt lgkmcnt(12)
    v_mfma_f32_32x32x16_bf16 v[112:127], v[44:47], v[140:143], v[112:127]
    ds_read_b64_tr_b16 v[40:41], v26 offset:18432
    ds_read_b64_tr_b16 v[42:43], v26 offset:19456
    s_waitcnt lgkmcnt(12)
    v_mfma_f32_32x32x16_bf16 v[64:79], v[48:51], v[144:147], v[64:79]
    ds_read_b64_tr_b16 v[44:45], v27 offset:18432
    ds_read_b64_tr_b16 v[46:47], v27 offset:19456
    s_waitcnt lgkmcnt(12)
    v_mfma_f32_32x32x16_bf16 v[80:95], v[52:55], v[144:147], v[80:95]
    v_subrev_u32 v24, 65536, v24
    ds_read_b64_tr_b16 v[48:49], v24 offset:0
    ds_read_b64_tr_b16 v[50:51], v24 offset:1024
    s_waitcnt lgkmcnt(12)
    v_mfma_f32_32x32x16_bf16 v[96:111], v[56:59], v[144:147], v[96:111]
    v_subrev_u32 v25, 65536, v25
    ds_read_b64_tr_b16 v[52:53], v25 offset:0
    ds_read_b64_tr_b16 v[54:55], v25 offset:1024
    s_waitcnt lgkmcnt(12)
    v_mfma_f32_32x32x16_bf16 v[112:127], v[60:63], v[144:147], v[112:127]
    v_subrev_u32 v26, 65536, v26
    ds_read_b64_tr_b16 v[56:57], v26 offset:0
    ds_read_b64_tr_b16 v[58:59], v26 offset:1024
    s_waitcnt lgkmcnt(12)
    v_mfma_f32_32x32x16_bf16 v[64:79], v[32:35], v[148:151], v[64:79]
    v_subrev_u32 v27, 65536, v27
    ds_read_b64_tr_b16 v[60:61], v27 offset:0
    ds_read_b64_tr_b16 v[62:63], v27 offset:1024
    s_waitcnt lgkmcnt(12)
    v_mfma_f32_32x32x16_bf16 v[80:95], v[36:39], v[148:151], v[80:95]
    ds_read_b64_tr_b16 v[32:33], v24 offset:2048
    ds_read_b64_tr_b16 v[34:35], v24 offset:3072
    s_waitcnt lgkmcnt(12)
    v_mfma_f32_32x32x16_bf16 v[96:111], v[40:43], v[148:151], v[96:111]
    ds_read_b64_tr_b16 v[36:37], v25 offset:2048
    ds_read_b64_tr_b16 v[38:39], v25 offset:3072
    s_waitcnt lgkmcnt(12)
    v_mfma_f32_32x32x16_bf16 v[112:127], v[44:47], v[148:151], v[112:127]
    ds_read_b64_tr_b16 v[40:41], v26 offset:2048
    ds_read_b64_tr_b16 v[42:43], v26 offset:3072
    s_waitcnt lgkmcnt(12)
    v_mfma_f32_32x32x16_bf16 v[64:79], v[48:51], v[152:155], v[64:79]
    ds_read_b64_tr_b16 v[44:45], v27 offset:2048
    ds_read_b64_tr_b16 v[46:47], v27 offset:3072
    s_waitcnt lgkmcnt(12)
    v_mfma_f32_32x32x16_bf16 v[80:95], v[52:55], v[152:155], v[80:95]
    ds_read_b64_tr_b16 v[48:49], v24 offset:8192
    ds_read_b64_tr_b16 v[50:51], v24 offset:9216
    s_waitcnt lgkmcnt(12)
    v_mfma_f32_32x32x16_bf16 v[96:111], v[56:59], v[152:155], v[96:111]
    ds_read_b64_tr_b16 v[52:53], v25 offset:8192
    ds_read_b64_tr_b16 v[54:55], v25 offset:9216
    s_waitcnt lgkmcnt(12)
    v_mfma_f32_32x32x16_bf16 v[112:127], v[60:63], v[152:155], v[112:127]
    ds_read_b64_tr_b16 v[56:57], v26 offset:8192
    ds_read_b64_tr_b16 v[58:59], v26 offset:9216
    s_waitcnt lgkmcnt(12)
    v_mfma_f32_32x32x16_bf16 v[64:79], v[32:35], v[156:159], v[64:79]
    ds_read_b64_tr_b16 v[60:61], v27 offset:8192
    ds_read_b64_tr_b16 v[62:63], v27 offset:9216
    s_waitcnt lgkmcnt(12)
    v_mfma_f32_32x32x16_bf16 v[80:95], v[36:39], v[156:159], v[80:95]
    ds_read_b64_tr_b16 v[32:33], v24 offset:10240
    ds_read_b64_tr_b16 v[34:35], v24 offset:11264
    s_waitcnt lgkmcnt(12)
    v_mfma_f32_32x32x16_bf16 v[96:111], v[40:43], v[156:159], v[96:111]
    ds_read_b64_tr_b16 v[36:37], v25 offset:10240
    ds_read_b64_tr_b16 v[38:39], v25 offset:11264
    s_waitcnt lgkmcnt(12)
    v_mfma_f32_32x32x16_bf16 v[112:127], v[44:47], v[156:159], v[112:127]
    ds_read_b64_tr_b16 v[40:41], v26 offset:10240
    ds_read_b64_tr_b16 v[42:43], v26 offset:11264
    s_waitcnt lgkmcnt(12)
    v_mfma_f32_32x32x16_bf16 v[64:79], v[48:51], v[160:163], v[64:79]
    s_waitcnt vmcnt(0)
    s_barrier
    ds_read_b64_tr_b16 v[44:45], v27 offset:10240
    ds_read_b64_tr_b16 v[46:47], v27 offset:11264
    s_waitcnt lgkmcnt(12)
    v_mfma_f32_32x32x16_bf16 v[80:95], v[52:55], v[160:163], v[80:95]
    ds_read_b64_tr_b16 v[48:49], v24 offset:16384
    ds_read_b64_tr_b16 v[50:51], v24 offset:17408
    s_waitcnt lgkmcnt(12)
    v_mfma_f32_32x32x16_bf16 v[96:111], v[56:59], v[160:163], v[96:111]
    ds_read_b64_tr_b16 v[52:53], v25 offset:16384
    ds_read_b64_tr_b16 v[54:55], v25 offset:17408
    s_waitcnt lgkmcnt(12)
    v_mfma_f32_32x32x16_bf16 v[112:127], v[60:63], v[160:163], v[112:127]
    ds_read_b64_tr_b16 v[56:57], v26 offset:16384
    ds_read_b64_tr_b16 v[58:59], v26 offset:17408
    s_waitcnt lgkmcnt(12)
    v_mfma_f32_32x32x16_bf16 v[64:79], v[32:35], v[164:167], v[64:79]
    ds_read_b64_tr_b16 v[60:61], v27 offset:16384
    ds_read_b64_tr_b16 v[62:63], v27 offset:17408
    s_waitcnt lgkmcnt(12)
    v_mfma_f32_32x32x16_bf16 v[80:95], v[36:39], v[164:167], v[80:95]
    ds_read_b64_tr_b16 v[32:33], v24 offset:18432
    ds_read_b64_tr_b16 v[34:35], v24 offset:19456
    s_waitcnt lgkmcnt(12)
    v_mfma_f32_32x32x16_bf16 v[96:111], v[40:43], v[164:167], v[96:111]
    ds_read_b64_tr_b16 v[36:37], v25 offset:18432
    ds_read_b64_tr_b16 v[38:39], v25 offset:19456
    s_waitcnt lgkmcnt(12)
    v_mfma_f32_32x32x16_bf16 v[112:127], v[44:47], v[164:167], v[112:127]
    ds_read_b64_tr_b16 v[40:41], v26 offset:18432
    ds_read_b64_tr_b16 v[42:43], v26 offset:19456
    s_waitcnt lgkmcnt(12)
    v_mfma_f32_32x32x16_bf16 v[64:79], v[48:51], v[168:171], v[64:79]
    ds_read_b64_tr_b16 v[44:45], v27 offset:18432
    ds_read_b64_tr_b16 v[46:47], v27 offset:19456
    s_waitcnt lgkmcnt(12)
    v_mfma_f32_32x32x16_bf16 v[80:95], v[52:55], v[168:171], v[80:95]
    ds_read_b64_tr_b16 v[48:49], v24 offset:24576
    ds_read_b64_tr_b16 v[50:51], v24 offset:25600
    s_waitcnt lgkmcnt(12)
    v_mfma_f32_32x32x16_bf16 v[96:111], v[56:59], v[168:171], v[96:111]
    ds_read_b64_tr_b16 v[52:53], v25 offset:24576
    ds_read_b64_tr_b16 v[54:55], v25 offset:25600
    s_waitcnt lgkmcnt(12)
    v_mfma_f32_32x32x16_bf16 v[112:127], v[60:63], v[168:171], v[112:127]
    ds_read_b64_tr_b16 v[56:57], v26 offset:24576
    ds_read_b64_tr_b16 v[58:59], v26 offset:25600
    s_waitcnt lgkmcnt(12)
    v_mfma_f32_32x32x16_bf16 v[64:79], v[32:35], v[172:175], v[64:79]
    ds_read_b64_tr_b16 v[60:61], v27 offset:24576
    ds_read_b64_tr_b16 v[62:63], v27 offset:25600
    s_waitcnt lgkmcnt(12)
    v_mfma_f32_32x32x16_bf16 v[80:95], v[36:39], v[172:175], v[80:95]
    ds_read_b64_tr_b16 v[32:33], v24 offset:26624
    ds_read_b64_tr_b16 v[34:35], v24 offset:27648
    s_waitcnt lgkmcnt(12)
    v_mfma_f32_32x32x16_bf16 v[96:111], v[40:43], v[172:175], v[96:111]
    ds_read_b64_tr_b16 v[36:37], v25 offset:26624
    ds_read_b64_tr_b16 v[38:39], v25 offset:27648
    s_waitcnt lgkmcnt(12)
    v_mfma_f32_32x32x16_bf16 v[112:127], v[44:47], v[172:175], v[112:127]
    ds_read_b64_tr_b16 v[40:41], v26 offset:26624
    ds_read_b64_tr_b16 v[42:43], v26 offset:27648
    s_waitcnt lgkmcnt(12)
    v_mfma_f32_32x32x16_bf16 v[64:79], v[48:51], v[176:179], v[64:79]
    ds_read_b64_tr_b16 v[44:45], v27 offset:26624
    ds_read_b64_tr_b16 v[46:47], v27 offset:27648
    s_waitcnt lgkmcnt(12)
    v_mfma_f32_32x32x16_bf16 v[80:95], v[52:55], v[176:179], v[80:95]
    ds_read_b64_tr_b16 v[48:49], v24 offset:32768
    ds_read_b64_tr_b16 v[50:51], v24 offset:33792
    s_waitcnt lgkmcnt(12)
    v_mfma_f32_32x32x16_bf16 v[96:111], v[56:59], v[176:179], v[96:111]
    ds_read_b64_tr_b16 v[52:53], v25 offset:32768
    ds_read_b64_tr_b16 v[54:55], v25 offset:33792
    s_waitcnt lgkmcnt(12)
    v_mfma_f32_32x32x16_bf16 v[112:127], v[60:63], v[176:179], v[112:127]
    ds_read_b64_tr_b16 v[56:57], v26 offset:32768
    ds_read_b64_tr_b16 v[58:59], v26 offset:33792
    s_waitcnt lgkmcnt(12)
    v_mfma_f32_32x32x16_bf16 v[64:79], v[32:35], v[180:183], v[64:79]
    ds_read_b64_tr_b16 v[60:61], v27 offset:32768
    ds_read_b64_tr_b16 v[62:63], v27 offset:33792
    s_waitcnt lgkmcnt(12)
    v_mfma_f32_32x32x16_bf16 v[80:95], v[36:39], v[180:183], v[80:95]
    ds_read_b64_tr_b16 v[32:33], v24 offset:34816
    ds_read_b64_tr_b16 v[34:35], v24 offset:35840
    s_waitcnt lgkmcnt(12)
    v_mfma_f32_32x32x16_bf16 v[96:111], v[40:43], v[180:183], v[96:111]
    ds_read_b64_tr_b16 v[36:37], v25 offset:34816
    ds_read_b64_tr_b16 v[38:39], v25 offset:35840
    s_waitcnt lgkmcnt(12)
    v_mfma_f32_32x32x16_bf16 v[112:127], v[44:47], v[180:183], v[112:127]
    ds_read_b64_tr_b16 v[40:41], v26 offset:34816
    ds_read_b64_tr_b16 v[42:43], v26 offset:35840
    s_waitcnt lgkmcnt(12)
    v_mfma_f32_32x32x16_bf16 v[64:79], v[48:51], v[184:187], v[64:79]
    ds_read_b64_tr_b16 v[44:45], v27 offset:34816
    ds_read_b64_tr_b16 v[46:47], v27 offset:35840
    s_waitcnt lgkmcnt(12)
    v_mfma_f32_32x32x16_bf16 v[80:95], v[52:55], v[184:187], v[80:95]
    ds_read_b64_tr_b16 v[48:49], v24 offset:40960
    ds_read_b64_tr_b16 v[50:51], v24 offset:41984
    s_waitcnt lgkmcnt(12)
    v_mfma_f32_32x32x16_bf16 v[96:111], v[56:59], v[184:187], v[96:111]
    ds_read_b64_tr_b16 v[52:53], v25 offset:40960
    ds_read_b64_tr_b16 v[54:55], v25 offset:41984
    s_waitcnt lgkmcnt(12)
    v_mfma_f32_32x32x16_bf16 v[112:127], v[60:63], v[184:187], v[112:127]
    ds_read_b64_tr_b16 v[56:57], v26 offset:40960
    ds_read_b64_tr_b16 v[58:59], v26 offset:41984
    s_waitcnt lgkmcnt(12)
    v_mfma_f32_32x32x16_bf16 v[64:79], v[32:35], v[188:191], v[64:79]
    ds_read_b64_tr_b16 v[60:61], v27 offset:40960
    ds_read_b64_tr_b16 v[62:63], v27 offset:41984
    s_waitcnt lgkmcnt(12)
    v_mfma_f32_32x32x16_bf16 v[80:95], v[36:39], v[188:191], v[80:95]
    ds_read_b64_tr_b16 v[32:33], v24 offset:43008
    ds_read_b64_tr_b16 v[34:35], v24 offset:44032
    s_waitcnt lgkmcnt(12)
    v_mfma_f32_32x32x16_bf16 v[96:111], v[40:43], v[188:191], v[96:111]
    ds_read_b64_tr_b16 v[36:37], v25 offset:43008
    ds_read_b64_tr_b16 v[38:39], v25 offset:44032
    s_waitcnt lgkmcnt(12)
    v_mfma_f32_32x32x16_bf16 v[112:127], v[44:47], v[188:191], v[112:127]
    ds_read_b64_tr_b16 v[40:41], v26 offset:43008
    ds_read_b64_tr_b16 v[42:43], v26 offset:44032
    s_waitcnt lgkmcnt(12)
    v_mfma_f32_32x32x16_bf16 v[64:79], v[48:51], v[192:195], v[64:79]
    s_barrier
    ds_read_b64_tr_b16 v[44:45], v27 offset:43008
    ds_read_b64_tr_b16 v[46:47], v27 offset:44032
    s_waitcnt lgkmcnt(12)
    v_mfma_f32_32x32x16_bf16 v[80:95], v[52:55], v[192:195], v[80:95]
    ds_read_b64_tr_b16 v[48:49], v24 offset:49152
    ds_read_b64_tr_b16 v[50:51], v24 offset:50176
    s_waitcnt lgkmcnt(12)
    v_mfma_f32_32x32x16_bf16 v[96:111], v[56:59], v[192:195], v[96:111]
    ds_read_b64_tr_b16 v[52:53], v25 offset:49152
    ds_read_b64_tr_b16 v[54:55], v25 offset:50176
    s_waitcnt lgkmcnt(12)
    v_mfma_f32_32x32x16_bf16 v[112:127], v[60:63], v[192:195], v[112:127]
    ds_read_b64_tr_b16 v[56:57], v26 offset:49152
    ds_read_b64_tr_b16 v[58:59], v26 offset:50176
    s_waitcnt lgkmcnt(12)
    v_mfma_f32_32x32x16_bf16 v[64:79], v[32:35], v[196:199], v[64:79]
    ds_read_b64_tr_b16 v[60:61], v27 offset:49152
    ds_read_b64_tr_b16 v[62:63], v27 offset:50176
    s_waitcnt lgkmcnt(12)
    v_mfma_f32_32x32x16_bf16 v[80:95], v[36:39], v[196:199], v[80:95]
    ds_read_b64_tr_b16 v[32:33], v24 offset:51200
    ds_read_b64_tr_b16 v[34:35], v24 offset:52224
    s_waitcnt lgkmcnt(12)
    v_mfma_f32_32x32x16_bf16 v[96:111], v[40:43], v[196:199], v[96:111]
    ds_read_b64_tr_b16 v[36:37], v25 offset:51200
    ds_read_b64_tr_b16 v[38:39], v25 offset:52224
    s_waitcnt lgkmcnt(12)
    v_mfma_f32_32x32x16_bf16 v[112:127], v[44:47], v[196:199], v[112:127]
    ds_read_b64_tr_b16 v[40:41], v26 offset:51200
    ds_read_b64_tr_b16 v[42:43], v26 offset:52224
    s_waitcnt lgkmcnt(12)
    v_mfma_f32_32x32x16_bf16 v[64:79], v[48:51], v[200:203], v[64:79]
    ds_read_b64_tr_b16 v[44:45], v27 offset:51200
    ds_read_b64_tr_b16 v[46:47], v27 offset:52224
    s_waitcnt lgkmcnt(12)
    v_mfma_f32_32x32x16_bf16 v[80:95], v[52:55], v[200:203], v[80:95]
    ds_read_b64_tr_b16 v[48:49], v24 offset:57344
    ds_read_b64_tr_b16 v[50:51], v24 offset:58368
    s_waitcnt lgkmcnt(12)
    v_mfma_f32_32x32x16_bf16 v[96:111], v[56:59], v[200:203], v[96:111]
    ds_read_b64_tr_b16 v[52:53], v25 offset:57344
    ds_read_b64_tr_b16 v[54:55], v25 offset:58368
    s_waitcnt lgkmcnt(12)
    v_mfma_f32_32x32x16_bf16 v[112:127], v[60:63], v[200:203], v[112:127]
    ds_read_b64_tr_b16 v[56:57], v26 offset:57344
    ds_read_b64_tr_b16 v[58:59], v26 offset:58368
    s_waitcnt lgkmcnt(12)
    v_mfma_f32_32x32x16_bf16 v[64:79], v[32:35], v[204:207], v[64:79]
    ds_read_b64_tr_b16 v[60:61], v27 offset:57344
    ds_read_b64_tr_b16 v[62:63], v27 offset:58368
    s_waitcnt lgkmcnt(12)
    v_mfma_f32_32x32x16_bf16 v[80:95], v[36:39], v[204:207], v[80:95]
    ds_read_b64_tr_b16 v[32:33], v24 offset:59392
    ds_read_b64_tr_b16 v[34:35], v24 offset:60416
    s_waitcnt lgkmcnt(12)
    v_mfma_f32_32x32x16_bf16 v[96:111], v[40:43], v[204:207], v[96:111]
    ds_read_b64_tr_b16 v[36:37], v25 offset:59392
    ds_read_b64_tr_b16 v[38:39], v25 offset:60416
    s_waitcnt lgkmcnt(12)
    v_mfma_f32_32x32x16_bf16 v[112:127], v[44:47], v[204:207], v[112:127]
    ds_read_b64_tr_b16 v[40:41], v26 offset:59392
    ds_read_b64_tr_b16 v[42:43], v26 offset:60416
    s_waitcnt lgkmcnt(12)
    v_mfma_f32_32x32x16_bf16 v[64:79], v[48:51], v[208:211], v[64:79]
    ds_read_b64_tr_b16 v[44:45], v27 offset:59392
    ds_read_b64_tr_b16 v[46:47], v27 offset:60416
    s_waitcnt lgkmcnt(12)
    v_mfma_f32_32x32x16_bf16 v[80:95], v[52:55], v[208:211], v[80:95]
    v_add_u32 v24, 65536, v24
    ds_read_b64_tr_b16 v[48:49], v24 offset:0
    ds_read_b64_tr_b16 v[50:51], v24 offset:1024
    s_waitcnt lgkmcnt(12)
    v_mfma_f32_32x32x16_bf16 v[96:111], v[56:59], v[208:211], v[96:111]
    v_add_u32 v25, 65536, v25
    ds_read_b64_tr_b16 v[52:53], v25 offset:0
    ds_read_b64_tr_b16 v[54:55], v25 offset:1024
    s_waitcnt lgkmcnt(12)
    v_mfma_f32_32x32x16_bf16 v[112:127], v[60:63], v[208:211], v[112:127]
    v_add_u32 v26, 65536, v26
    ds_read_b64_tr_b16 v[56:57], v26 offset:0
    ds_read_b64_tr_b16 v[58:59], v26 offset:1024
    s_waitcnt lgkmcnt(12)
    v_mfma_f32_32x32x16_bf16 v[64:79], v[32:35], v[212:215], v[64:79]
    v_add_u32 v27, 65536, v27
    ds_read_b64_tr_b16 v[60:61], v27 offset:0
    ds_read_b64_tr_b16 v[62:63], v27 offset:1024
    s_waitcnt lgkmcnt(12)
    v_mfma_f32_32x32x16_bf16 v[80:95], v[36:39], v[212:215], v[80:95]
    ds_read_b64_tr_b16 v[32:33], v24 offset:2048
    ds_read_b64_tr_b16 v[34:35], v24 offset:3072
    s_waitcnt lgkmcnt(12)
    v_mfma_f32_32x32x16_bf16 v[96:111], v[40:43], v[212:215], v[96:111]
    ds_read_b64_tr_b16 v[36:37], v25 offset:2048
    ds_read_b64_tr_b16 v[38:39], v25 offset:3072
    s_waitcnt lgkmcnt(12)
    v_mfma_f32_32x32x16_bf16 v[112:127], v[44:47], v[212:215], v[112:127]
    ds_read_b64_tr_b16 v[40:41], v26 offset:2048
    ds_read_b64_tr_b16 v[42:43], v26 offset:3072
    s_waitcnt lgkmcnt(12)
    v_mfma_f32_32x32x16_bf16 v[64:79], v[48:51], v[216:219], v[64:79]
    ds_read_b64_tr_b16 v[44:45], v27 offset:2048
    ds_read_b64_tr_b16 v[46:47], v27 offset:3072
    s_waitcnt lgkmcnt(12)
    v_mfma_f32_32x32x16_bf16 v[80:95], v[52:55], v[216:219], v[80:95]
    v_subrev_u32 v24, 131072, v24
    ds_read_b64_tr_b16 v[48:49], v24 offset:0
    ds_read_b64_tr_b16 v[50:51], v24 offset:1024
    s_waitcnt lgkmcnt(12)
    v_mfma_f32_32x32x16_bf16 v[96:111], v[56:59], v[216:219], v[96:111]
    v_subrev_u32 v25, 131072, v25
    ds_read_b64_tr_b16 v[52:53], v25 offset:0
    ds_read_b64_tr_b16 v[54:55], v25 offset:1024
    s_waitcnt lgkmcnt(12)
    v_mfma_f32_32x32x16_bf16 v[112:127], v[60:63], v[216:219], v[112:127]
    v_subrev_u32 v26, 131072, v26
    ds_read_b64_tr_b16 v[56:57], v26 offset:0
    ds_read_b64_tr_b16 v[58:59], v26 offset:1024
    s_waitcnt lgkmcnt(12)
    v_mfma_f32_32x32x16_bf16 v[64:79], v[32:35], v[220:223], v[64:79]
    v_subrev_u32 v27, 131072, v27
    ds_read_b64_tr_b16 v[60:61], v27 offset:0
    ds_read_b64_tr_b16 v[62:63], v27 offset:1024
    s_waitcnt lgkmcnt(12)
    v_mfma_f32_32x32x16_bf16 v[80:95], v[36:39], v[220:223], v[80:95]
    ds_read_b64_tr_b16 v[32:33], v24 offset:2048
    ds_read_b64_tr_b16 v[34:35], v24 offset:3072
    s_waitcnt lgkmcnt(12)
    v_mfma_f32_32x32x16_bf16 v[96:111], v[40:43], v[220:223], v[96:111]
    ds_read_b64_tr_b16 v[36:37], v25 offset:2048
    ds_read_b64_tr_b16 v[38:39], v25 offset:3072
    s_waitcnt lgkmcnt(12)
    v_mfma_f32_32x32x16_bf16 v[112:127], v[44:47], v[220:223], v[112:127]
    ds_read_b64_tr_b16 v[40:41], v26 offset:2048
    ds_read_b64_tr_b16 v[42:43], v26 offset:3072
    s_waitcnt lgkmcnt(12)
    v_mfma_f32_32x32x16_bf16 v[64:79], v[48:51], v[224:227], v[64:79]
    s_barrier
    v_mov_b32 v14, 4148
    ds_read_b32 v15, v14
    ds_read_b64_tr_b16 v[44:45], v27 offset:2048
    ds_read_b64_tr_b16 v[46:47], v27 offset:3072
    s_waitcnt lgkmcnt(13)
    v_mfma_f32_32x32x16_bf16 v[80:95], v[52:55], v[224:227], v[80:95]
    ds_read_b64_tr_b16 v[48:49], v24 offset:8192
    ds_read_b64_tr_b16 v[50:51], v24 offset:9216
    s_waitcnt lgkmcnt(13)
    v_mfma_f32_32x32x16_bf16 v[96:111], v[56:59], v[224:227], v[96:111]
    ds_read_b64_tr_b16 v[52:53], v24 offset:10240
    ds_read_b64_tr_b16 v[54:55], v24 offset:11264
    s_waitcnt lgkmcnt(13)
    v_mfma_f32_32x32x16_bf16 v[112:127], v[60:63], v[224:227], v[112:127]
    ds_read_b64_tr_b16 v[56:57], v24 offset:16384
    ds_read_b64_tr_b16 v[58:59], v24 offset:17408
    s_waitcnt lgkmcnt(13)
    v_mfma_f32_32x32x16_bf16 v[64:79], v[32:35], v[228:231], v[64:79]
    s_waitcnt lgkmcnt(8)
    v_readfirstlane_b32 s82, v15
    v_or_b32 v2, v15, v8
    s_mov_b32 s83, s86
    ds_read_b64_tr_b16 v[60:61], v24 offset:18432
    ds_read_b64_tr_b16 v[62:63], v24 offset:19456
    v_mfma_f32_32x32x16_bf16 v[80:95], v[36:39], v[228:231], v[80:95]
    ds_read_b64_tr_b16 v[32:33], v24 offset:24576
    ds_read_b64_tr_b16 v[34:35], v24 offset:25600
    v_mfma_f32_32x32x16_bf16 v[96:111], v[40:43], v[228:231], v[96:111]
    ds_read_b64_tr_b16 v[36:37], v24 offset:26624
    ds_read_b64_tr_b16 v[38:39], v24 offset:27648
    s_waitcnt lgkmcnt(12)
    v_mfma_f32_32x32x16_bf16 v[112:127], v[44:47], v[228:231], v[112:127]
    ds_read_b128 v[40:43], v10 offset:6144
    s_waitcnt lgkmcnt(11)
    v_mfma_f32_32x32x16_bf16 v[64:79], v[48:51], v[232:235], v[64:79]
    ds_read_b64_tr_b16 v[44:45], v25 offset:8192
    ds_read_b64_tr_b16 v[46:47], v25 offset:9216
    s_add_u32 s87, s91, s86
    s_add_u32 s86, s86, 8192
    s_cmp_ge_u32 s86, 114688
    s_cselect_b32 s86, 0, s86
    buffer_load_dwordx4 v[128:131], v2, s[60:63], s87 offen offset:0 sc1
    s_waitcnt lgkmcnt(11)
    v_mfma_f32_32x32x16_bf16 v[64:79], v[52:55], v[236:239], v[64:79]
    ds_read_b64_tr_b16 v[48:49], v25 offset:10240
    ds_read_b64_tr_b16 v[50:51], v25 offset:11264
    buffer_load_dwordx4 v[132:135], v2, s[60:63], s87 offen offset:1024 sc1
    s_waitcnt lgkmcnt(11)
    v_mfma_f32_32x32x16_bf16 v[64:79], v[56:59], v[240:243], v[64:79]
    ds_read_b64_tr_b16 v[52:53], v25 offset:16384
    ds_read_b64_tr_b16 v[54:55], v25 offset:17408
    s_add_u32 s87, s91, s86
    s_add_u32 s86, s86, 8192
    s_cmp_ge_u32 s86, 114688
    s_cselect_b32 s86, 0, s86
    buffer_load_dwordx4 v[136:139], v2, s[60:63], s87 offen offset:0 sc1
    s_waitcnt lgkmcnt(11)
    v_mfma_f32_32x32x16_bf16 v[64:79], v[60:63], v[244:247], v[64:79]
    ds_read_b64_tr_b16 v[56:57], v25 offset:18432
    ds_read_b64_tr_b16 v[58:59], v25 offset:19456
    buffer_load_dwordx4 v[140:143], v2, s[60:63], s87 offen offset:1024 sc1
    s_waitcnt lgkmcnt(11)
    v_mfma_f32_32x32x16_bf16 v[64:79], v[32:35], v[248:251], v[64:79]
    ds_read_b64_tr_b16 v[60:61], v25 offset:24576
    ds_read_b64_tr_b16 v[62:63], v25 offset:25600
    s_add_u32 s87, s91, s86
    s_add_u32 s86, s86, 8192
    s_cmp_ge_u32 s86, 114688
    s_cselect_b32 s86, 0, s86
    buffer_load_dwordx4 v[144:147], v2, s[60:63], s87 offen offset:0 sc1
    s_waitcnt lgkmcnt(11)
    v_mfma_f32_32x32x16_bf16 v[64:79], v[36:39], v[252:255], v[64:79]
    ds_read_b64_tr_b16 v[32:33], v25 offset:26624
    ds_read_b64_tr_b16 v[34:35], v25 offset:27648
    buffer_load_dwordx4 v[148:151], v2, s[60:63], s87 offen offset:1024 sc1
    s_waitcnt lgkmcnt(12)
    v_mfma_f32_32x32x16_bf16 v[64:79], v[40:43], v[28:31], v[64:79]
    s_add_u32 s85, s90, 4096
    ds_read_b128 v[36:39], v10 offset:6656
    s_add_u32 s87, s91, s86
    s_add_u32 s86, s86, 8192
    s_cmp_ge_u32 s86, 114688
    s_cselect_b32 s86, 0, s86
    buffer_load_dwordx4 v[152:155], v2, s[60:63], s87 offen offset:0 sc1
    s_waitcnt lgkmcnt(11)
    v_mfma_f32_32x32x16_bf16 v[80:95], v[44:47], v[232:235], v[80:95]
    ds_read_b64_tr_b16 v[40:41], v26 offset:8192
    ds_read_b64_tr_b16 v[42:43], v26 offset:9216
    buffer_load_dwordx4 v[156:159], v2, s[60:63], s87 offen offset:1024 sc1
    s_waitcnt lgkmcnt(11)
    v_mfma_f32_32x32x16_bf16 v[80:95], v[48:51], v[236:239], v[80:95]
    ds_read_b64_tr_b16 v[44:45], v26 offset:10240
    ds_read_b64_tr_b16 v[46:47], v26 offset:11264
    v_mul_f32 v64, v64, v72
    v_mul_f32 v65, v65, v73
    v_mul_f32 v66, v66, v74
    v_mul_f32 v67, v67, v75
    s_waitcnt lgkmcnt(11)
    v_mfma_f32_32x32x16_bf16 v[80:95], v[52:55], v[240:243], v[80:95]
    ds_read_b64_tr_b16 v[48:49], v26 offset:16384
    ds_read_b64_tr_b16 v[50:51], v26 offset:17408
    v_mul_f32 v68, v68, v76
    v_mul_f32 v69, v69, v77
    v_mul_f32 v70, v70, v78
    v_mul_f32 v71, v71, v79
    s_waitcnt lgkmcnt(11)
    v_mfma_f32_32x32x16_bf16 v[80:95], v[56:59], v[244:247], v[80:95]
    ds_read_b64_tr_b16 v[52:53], v26 offset:18432
    ds_read_b64_tr_b16 v[54:55], v26 offset:19456
    v_mul_f32 v64, v64, v13
    v_mul_f32 v65, v65, v13
    v_mul_f32 v66, v66, v13
    v_mul_f32 v67, v67, v13
    s_waitcnt lgkmcnt(11)
    v_mfma_f32_32x32x16_bf16 v[80:95], v[60:63], v[248:251], v[80:95]
    ds_read_b64_tr_b16 v[56:57], v26 offset:24576
    ds_read_b64_tr_b16 v[58:59], v26 offset:25600
    v_mul_f32 v68, v68, v13
    v_mul_f32 v69, v69, v13
    v_mul_f32 v70, v70, v13
    v_mul_f32 v71, v71, v13
    s_waitcnt lgkmcnt(11)
    v_mfma_f32_32x32x16_bf16 v[80:95], v[32:35], v[252:255], v[80:95]
    ds_read_b64_tr_b16 v[60:61], v26 offset:26624
    ds_read_b64_tr_b16 v[62:63], v26 offset:27648
    v_cvt_pk_bf16_f32 v72, v64, v65
    v_cvt_pk_bf16_f32 v73, v66, v67
    v_cvt_pk_bf16_f32 v74, v68, v69
    v_cvt_pk_bf16_f32 v75, v70, v71
    s_waitcnt lgkmcnt(12)
    v_mfma_f32_32x32x16_bf16 v[80:95], v[36:39], v[28:31], v[80:95]
    ds_read_b128 v[32:35], v10 offset:7168
    buffer_store_dwordx4 v[72:75], v8, s[60:63], s85 offen offset:0 sc1
    s_waitcnt lgkmcnt(11)
    v_mfma_f32_32x32x16_bf16 v[96:111], v[40:43], v[232:235], v[96:111]
    ds_read_b64_tr_b16 v[36:37], v27 offset:8192
    ds_read_b64_tr_b16 v[38:39], v27 offset:9216
    s_waitcnt lgkmcnt(11)
    v_mfma_f32_32x32x16_bf16 v[96:111], v[44:47], v[236:239], v[96:111]
    ds_read_b64_tr_b16 v[40:41], v27 offset:10240
    ds_read_b64_tr_b16 v[42:43], v27 offset:11264
    s_waitcnt lgkmcnt(11)
    v_mfma_f32_32x32x16_bf16 v[96:111], v[48:51], v[240:243], v[96:111]
    ds_read_b64_tr_b16 v[44:45], v27 offset:16384
    ds_read_b64_tr_b16 v[46:47], v27 offset:17408
    v_mul_f32 v80, v80, v88
    v_mul_f32 v81, v81, v89
    v_mul_f32 v82, v82, v90
    v_mul_f32 v83, v83, v91
    s_waitcnt lgkmcnt(11)
    v_mfma_f32_32x32x16_bf16 v[96:111], v[52:55], v[244:247], v[96:111]
    ds_read_b64_tr_b16 v[48:49], v27 offset:18432
    ds_read_b64_tr_b16 v[50:51], v27 offset:19456
    v_mul_f32 v84, v84, v92
    v_mul_f32 v85, v85, v93
    v_mul_f32 v86, v86, v94
    v_mul_f32 v87, v87, v95
    s_waitcnt lgkmcnt(11)
    v_mfma_f32_32x32x16_bf16 v[96:111], v[56:59], v[248:251], v[96:111]
    ds_read_b64_tr_b16 v[52:53], v27 offset:24576
    ds_read_b64_tr_b16 v[54:55], v27 offset:25600
    v_mul_f32 v80, v80, v13
    v_mul_f32 v81, v81, v13
    v_mul_f32 v82, v82, v13
    v_mul_f32 v83, v83, v13
    s_waitcnt lgkmcnt(11)
    v_mfma_f32_32x32x16_bf16 v[96:111], v[60:63], v[252:255], v[96:111]
    ds_read_b64_tr_b16 v[56:57], v27 offset:26624
    ds_read_b64_tr_b16 v[58:59], v27 offset:27648
    v_mul_f32 v84, v84, v13
    v_mul_f32 v85, v85, v13
    v_mul_f32 v86, v86, v13
    v_mul_f32 v87, v87, v13
    s_waitcnt lgkmcnt(12)
    v_mfma_f32_32x32x16_bf16 v[96:111], v[32:35], v[28:31], v[96:111]
    ds_read_b128 v[60:63], v10 offset:7680
    v_cvt_pk_bf16_f32 v88, v80, v81
    v_cvt_pk_bf16_f32 v89, v82, v83
    v_cvt_pk_bf16_f32 v90, v84, v85
    v_cvt_pk_bf16_f32 v91, v86, v87
    s_waitcnt lgkmcnt(11)
    v_mfma_f32_32x32x16_bf16 v[112:127], v[36:39], v[232:235], v[112:127]
    buffer_store_dwordx4 v[88:91], v8, s[60:63], s85 offen offset:1024 sc1
    s_waitcnt lgkmcnt(9)
    v_mfma_f32_32x32x16_bf16 v[112:127], v[40:43], v[236:239], v[112:127]
    s_waitcnt lgkmcnt(7)
    v_mfma_f32_32x32x16_bf16 v[112:127], v[44:47], v[240:243], v[112:127]
    v_mul_f32 v96, v96, v104
    v_mul_f32 v97, v97, v105
    v_mul_f32 v98, v98, v106
    v_mul_f32 v99, v99, v107
    s_waitcnt lgkmcnt(5)
    v_mfma_f32_32x32x16_bf16 v[112:127], v[48:51], v[244:247], v[112:127]
    v_mul_f32 v100, v100, v108
    v_mul_f32 v101, v101, v109
    v_mul_f32 v102, v102, v110
    v_mul_f32 v103, v103, v111
    s_waitcnt lgkmcnt(3)
    v_mfma_f32_32x32x16_bf16 v[112:127], v[52:55], v[248:251], v[112:127]
    v_mul_f32 v96, v96, v13
    v_mul_f32 v97, v97, v13
    v_mul_f32 v98, v98, v13
    v_mul_f32 v99, v99, v13
    s_waitcnt lgkmcnt(1)
    v_mfma_f32_32x32x16_bf16 v[112:127], v[56:59], v[252:255], v[112:127]
    v_mul_f32 v100, v100, v13
    v_mul_f32 v101, v101, v13
    v_mul_f32 v102, v102, v13
    v_mul_f32 v103, v103, v13
    s_waitcnt lgkmcnt(0)
    v_mfma_f32_32x32x16_bf16 v[112:127], v[60:63], v[28:31], v[112:127]
    v_cvt_pk_bf16_f32 v104, v96, v97
    v_cvt_pk_bf16_f32 v105, v98, v99
    v_cvt_pk_bf16_f32 v106, v100, v101
    v_cvt_pk_bf16_f32 v107, v102, v103
    buffer_store_dwordx4 v[104:107], v8, s[60:63], s85 offen offset:2048 sc1
    s_nop 6
    v_pk_mul_f32 v[112:113], v[112:113], v[120:121]
    s_nop 4
    v_pk_mul_f32 v[114:115], v[114:115], v[122:123]
    s_nop 2
    v_pk_mul_f32 v[116:117], v[116:117], v[124:125]
    s_nop 0
    v_pk_mul_f32 v[118:119], v[118:119], v[126:127]
    v_pk_mul_f32 v[112:113], v[112:113], v[12:13] op_sel:[0,1] op_sel_hi:[1,1]
    v_pk_mul_f32 v[114:115], v[114:115], v[12:13] op_sel:[0,1] op_sel_hi:[1,1]
    v_pk_mul_f32 v[116:117], v[116:117], v[12:13] op_sel:[0,1] op_sel_hi:[1,1]
    v_pk_mul_f32 v[118:119], v[118:119], v[12:13] op_sel:[0,1] op_sel_hi:[1,1]
    v_cvt_pk_bf16_f32 v120, v112, v113
    v_cvt_pk_bf16_f32 v121, v114, v115
    v_cvt_pk_bf16_f32 v122, v116, v117
    v_cvt_pk_bf16_f32 v123, v118, v119
    buffer_store_dwordx4 v[120:123], v8, s[60:63], s85 offen offset:3072 sc1
    s_barrier
    s_cmp_eq_u32 s82, 0
    s_cbranch_scc1 L_p4
    s_mov_b32 s86, s83
L_p4r:
    v_mov_b32 v2, v8
    s_add_u32 s87, s91, s86
    s_add_u32 s86, s86, 8192
    s_cmp_ge_u32 s86, 114688
    s_cselect_b32 s86, 0, s86
    buffer_load_dwordx4 v[128:131], v2, s[60:63], s87 offen offset:0 sc1
    buffer_load_dwordx4 v[132:135], v2, s[60:63], s87 offen offset:1024 sc1
    s_add_u32 s87, s91, s86
    s_add_u32 s86, s86, 8192
    s_cmp_ge_u32 s86, 114688
    s_cselect_b32 s86, 0, s86
    buffer_load_dwordx4 v[136:139], v2, s[60:63], s87 offen offset:0 sc1
    buffer_load_dwordx4 v[140:143], v2, s[60:63], s87 offen offset:1024 sc1
    s_add_u32 s87, s91, s86
    s_add_u32 s86, s86, 8192
    s_cmp_ge_u32 s86, 114688
    s_cselect_b32 s86, 0, s86
    buffer_load_dwordx4 v[144:147], v2, s[60:63], s87 offen offset:0 sc1
    buffer_load_dwordx4 v[148:151], v2, s[60:63], s87 offen offset:1024 sc1
    s_add_u32 s87, s91, s86
    s_add_u32 s86, s86, 8192
    s_cmp_ge_u32 s86, 114688
    s_cselect_b32 s86, 0, s86
    buffer_load_dwordx4 v[152:155], v2, s[60:63], s87 offen offset:0 sc1
    buffer_load_dwordx4 v[156:159], v2, s[60:63], s87 offen offset:1024 sc1
L_p4:
    v_xor_b32 v10, 64, v9
    ds_read_b128 v[112:115], v12 offset:4864
    ds_read_b128 v[116:119], v12 offset:4896
    ds_read_b128 v[120:123], v12 offset:4928
    ds_read_b128 v[124:127], v12 offset:4960
    ds_read_b64_tr_b16 v[64:65], v10 offset:32768
    ds_read_b64_tr_b16 v[66:67], v10 offset:33792
    ds_read_b64_tr_b16 v[68:69], v9 offset:32768
    ds_read_b64_tr_b16 v[70:71], v9 offset:33792
    ds_read_b64_tr_b16 v[72:73], v10 offset:34816
    ds_read_b64_tr_b16 v[74:75], v10 offset:35840
    ds_read_b64_tr_b16 v[76:77], v9 offset:34816
    ds_read_b64_tr_b16 v[78:79], v9 offset:35840
    ds_read_b64_tr_b16 v[80:81], v10 offset:40960
    ds_read_b64_tr_b16 v[82:83], v10 offset:41984
    ds_read_b64_tr_b16 v[84:85], v9 offset:40960
    ds_read_b64_tr_b16 v[86:87], v9 offset:41984
    s_waitcnt vmcnt(7)
    s_waitcnt lgkmcnt(10)
    v_mfma_f32_32x32x16_bf16 v[48:63], v[64:67], v[128:131], 0
    s_add_u32 s87, s91, s86
    s_add_u32 s86, s86, 8192
    s_cmp_ge_u32 s86, 114688
    s_cselect_b32 s86, 0, s86
    buffer_load_dwordx4 v[160:163], v2, s[60:63], s87 offen offset:0 sc1
    s_waitcnt lgkmcnt(8)
    v_mfma_f32_32x32x16_bf16 v[32:47], v[68:71], v[128:131], 0
    ds_read_b64_tr_b16 v[88:89], v10 offset:43008
    ds_read_b64_tr_b16 v[90:91], v10 offset:44032
    ds_read_b64_tr_b16 v[92:93], v9 offset:43008
    ds_read_b64_tr_b16 v[94:95], v9 offset:44032
    s_waitcnt vmcnt(7)
    s_waitcnt lgkmcnt(10)
    v_mfma_f32_32x32x16_bf16 v[48:63], v[72:75], v[132:135], v[48:63]
    buffer_load_dwordx4 v[164:167], v2, s[60:63], s87 offen offset:1024 sc1
    s_waitcnt lgkmcnt(8)
    v_mfma_f32_32x32x16_bf16 v[32:47], v[76:79], v[132:135], v[32:47]
    ds_read_b64_tr_b16 v[96:97], v10 offset:49152
    ds_read_b64_tr_b16 v[98:99], v10 offset:50176
    ds_read_b64_tr_b16 v[100:101], v9 offset:49152
    ds_read_b64_tr_b16 v[102:103], v9 offset:50176
    s_waitcnt vmcnt(7)
    s_waitcnt lgkmcnt(10)
    v_mfma_f32_32x32x16_bf16 v[48:63], v[80:83], v[136:139], v[48:63]
    s_add_u32 s87, s91, s86
    s_add_u32 s86, s86, 8192
    s_cmp_ge_u32 s86, 114688
    s_cselect_b32 s86, 0, s86
    buffer_load_dwordx4 v[168:171], v2, s[60:63], s87 offen offset:0 sc1
    s_waitcnt lgkmcnt(8)
    v_mfma_f32_32x32x16_bf16 v[32:47], v[84:87], v[136:139], v[32:47]
    ds_read_b64_tr_b16 v[64:65], v10 offset:51200
    ds_read_b64_tr_b16 v[66:67], v10 offset:52224
    ds_read_b64_tr_b16 v[68:69], v9 offset:51200
    ds_read_b64_tr_b16 v[70:71], v9 offset:52224
    s_waitcnt vmcnt(7)
    s_waitcnt lgkmcnt(10)
    v_mfma_f32_32x32x16_bf16 v[48:63], v[88:91], v[140:143], v[48:63]
    s_waitcnt vmcnt(3)
    s_barrier
    buffer_load_dwordx4 v[172:175], v2, s[60:63], s87 offen offset:1024 sc1
    s_waitcnt lgkmcnt(8)
    v_mfma_f32_32x32x16_bf16 v[32:47], v[92:95], v[140:143], v[32:47]
    ds_read_b64_tr_b16 v[72:73], v10 offset:57344
    ds_read_b64_tr_b16 v[74:75], v10 offset:58368
    ds_read_b64_tr_b16 v[76:77], v9 offset:57344
    ds_read_b64_tr_b16 v[78:79], v9 offset:58368
    s_waitcnt lgkmcnt(10)
    v_mfma_f32_32x32x16_bf16 v[48:63], v[96:99], v[144:147], v[48:63]
    s_add_u32 s87, s91, s86
    s_add_u32 s86, s86, 8192
    s_cmp_ge_u32 s86, 114688
    s_cselect_b32 s86, 0, s86
    buffer_load_dwordx4 v[176:179], v2, s[60:63], s87 offen offset:0 sc1
    s_waitcnt lgkmcnt(8)
    v_mfma_f32_32x32x16_bf16 v[32:47], v[100:103], v[144:147], v[32:47]
    ds_read_b64_tr_b16 v[80:81], v10 offset:59392
    ds_read_b64_tr_b16 v[82:83], v10 offset:60416
    ds_read_b64_tr_b16 v[84:85], v9 offset:59392
    ds_read_b64_tr_b16 v[86:87], v9 offset:60416
    s_waitcnt lgkmcnt(10)
    v_mfma_f32_32x32x16_bf16 v[48:63], v[64:67], v[148:151], v[48:63]
    buffer_load_dwordx4 v[180:183], v2, s[60:63], s87 offen offset:1024 sc1
    s_waitcnt lgkmcnt(8)
    v_mfma_f32_32x32x16_bf16 v[32:47], v[68:71], v[148:151], v[32:47]
    v_add_u32 v9, 131072, v9
    v_add_u32 v10, 131072, v10
    ds_read_b64_tr_b16 v[88:89], v10 offset:8192
    ds_read_b64_tr_b16 v[90:91], v10 offset:9216
    ds_read_b64_tr_b16 v[92:93], v9 offset:8192
    ds_read_b64_tr_b16 v[94:95], v9 offset:9216
    s_waitcnt lgkmcnt(10)
    v_mfma_f32_32x32x16_bf16 v[48:63], v[72:75], v[152:155], v[48:63]
    s_add_u32 s87, s91, s86
    s_add_u32 s86, s86, 8192
    s_cmp_ge_u32 s86, 114688
    s_cselect_b32 s86, 0, s86
    buffer_load_dwordx4 v[184:187], v2, s[60:63], s87 offen offset:0 sc1
    s_waitcnt lgkmcnt(8)
    v_mfma_f32_32x32x16_bf16 v[32:47], v[76:79], v[152:155], v[32:47]
    ds_read_b64_tr_b16 v[96:97], v10 offset:10240
    ds_read_b64_tr_b16 v[98:99], v10 offset:11264
    ds_read_b64_tr_b16 v[100:101], v9 offset:10240
    ds_read_b64_tr_b16 v[102:103], v9 offset:11264
    s_waitcnt lgkmcnt(10)
    v_mfma_f32_32x32x16_bf16 v[48:63], v[80:83], v[156:159], v[48:63]
    buffer_load_dwordx4 v[188:191], v2, s[60:63], s87 offen offset:1024 sc1
    s_waitcnt lgkmcnt(8)
    v_mfma_f32_32x32x16_bf16 v[32:47], v[84:87], v[156:159], v[32:47]
    ds_read_b64_tr_b16 v[64:65], v10 offset:16384
    ds_read_b64_tr_b16 v[66:67], v10 offset:17408
    ds_read_b64_tr_b16 v[68:69], v9 offset:16384
    ds_read_b64_tr_b16 v[70:71], v9 offset:17408
    s_waitcnt vmcnt(7)
    s_waitcnt lgkmcnt(10)
    v_mfma_f32_32x32x16_bf16 v[48:63], v[88:91], v[160:163], v[48:63]
    s_barrier
    s_add_u32 s87, s91, s86
    s_add_u32 s86, s86, 8192
    s_cmp_ge_u32 s86, 114688
    s_cselect_b32 s86, 0, s86
    buffer_load_dwordx4 v[192:195], v2, s[60:63], s87 offen offset:0 sc1
    s_waitcnt lgkmcnt(8)
    v_mfma_f32_32x32x16_bf16 v[32:47], v[92:95], v[160:163], v[32:47]
    ds_read_b64_tr_b16 v[72:73], v10 offset:18432
    ds_read_b64_tr_b16 v[74:75], v10 offset:19456
    ds_read_b64_tr_b16 v[76:77], v9 offset:18432
    ds_read_b64_tr_b16 v[78:79], v9 offset:19456
    s_waitcnt vmcnt(7)
    s_waitcnt lgkmcnt(10)
    v_mfma_f32_32x32x16_bf16 v[48:63], v[96:99], v[164:167], v[48:63]
    buffer_load_dwordx4 v[196:199], v2, s[60:63], s87 offen offset:1024 sc1
    s_waitcnt lgkmcnt(8)
    v_mfma_f32_32x32x16_bf16 v[32:47], v[100:103], v[164:167], v[32:47]
    v_subrev_u32 v9, 65536, v9
    v_subrev_u32 v10, 65536, v10
    ds_read_b64_tr_b16 v[80:81], v10 offset:0
    ds_read_b64_tr_b16 v[82:83], v10 offset:1024
    ds_read_b64_tr_b16 v[84:85], v9 offset:0
    ds_read_b64_tr_b16 v[86:87], v9 offset:1024
    s_waitcnt vmcnt(7)
    s_waitcnt lgkmcnt(10)
    v_mfma_f32_32x32x16_bf16 v[48:63], v[64:67], v[168:171], v[48:63]
    s_add_u32 s87, s91, s86
    s_add_u32 s86, s86, 8192
    s_cmp_ge_u32 s86, 114688
    s_cselect_b32 s86, 0, s86
    buffer_load_dwordx4 v[200:203], v2, s[60:63], s87 offen offset:0 sc1
    s_waitcnt lgkmcnt(8)
    v_mfma_f32_32x32x16_bf16 v[32:47], v[68:71], v[168:171], v[32:47]
    ds_read_b64_tr_b16 v[88:89], v10 offset:2048
    ds_read_b64_tr_b16 v[90:91], v10 offset:3072
    ds_read_b64_tr_b16 v[92:93], v9 offset:2048
    ds_read_b64_tr_b16 v[94:95], v9 offset:3072
    s_waitcnt vmcnt(7)
    s_waitcnt lgkmcnt(10)
    v_mfma_f32_32x32x16_bf16 v[48:63], v[72:75], v[172:175], v[48:63]
    buffer_load_dwordx4 v[204:207], v2, s[60:63], s87 offen offset:1024 sc1
    s_waitcnt lgkmcnt(8)
    v_mfma_f32_32x32x16_bf16 v[32:47], v[76:79], v[172:175], v[32:47]
    ds_read_b64_tr_b16 v[96:97], v10 offset:8192
    ds_read_b64_tr_b16 v[98:99], v10 offset:9216
    ds_read_b64_tr_b16 v[100:101], v9 offset:8192
    ds_read_b64_tr_b16 v[102:103], v9 offset:9216
    s_waitcnt vmcnt(7)
    s_waitcnt lgkmcnt(10)
    v_mfma_f32_32x32x16_bf16 v[48:63], v[80:83], v[176:179], v[48:63]
    s_add_u32 s87, s91, s86
    s_add_u32 s86, s86, 8192
    s_cmp_ge_u32 s86, 114688
    s_cselect_b32 s86, 0, s86
    buffer_load_dwordx4 v[208:211], v2, s[60:63], s87 offen offset:0 sc1
    s_waitcnt lgkmcnt(8)
    v_mfma_f32_32x32x16_bf16 v[32:47], v[84:87], v[176:179], v[32:47]
    ds_read_b64_tr_b16 v[64:65], v10 offset:10240
    ds_read_b64_tr_b16 v[66:67], v10 offset:11264
    ds_read_b64_tr_b16 v[68:69], v9 offset:10240
    ds_read_b64_tr_b16 v[70:71], v9 offset:11264
    s_waitcnt vmcnt(7)
    s_waitcnt lgkmcnt(10)
    v_mfma_f32_32x32x16_bf16 v[48:63], v[88:91], v[180:183], v[48:63]
    buffer_load_dwordx4 v[212:215], v2, s[60:63], s87 offen offset:1024 sc1
    s_waitcnt lgkmcnt(8)
    v_mfma_f32_32x32x16_bf16 v[32:47], v[92:95], v[180:183], v[32:47]
    ds_read_b64_tr_b16 v[72:73], v10 offset:16384
    ds_read_b64_tr_b16 v[74:75], v10 offset:17408
    ds_read_b64_tr_b16 v[76:77], v9 offset:16384
    ds_read_b64_tr_b16 v[78:79], v9 offset:17408
    s_waitcnt vmcnt(7)
    s_waitcnt lgkmcnt(10)
    v_mfma_f32_32x32x16_bf16 v[48:63], v[96:99], v[184:187], v[48:63]
    s_add_u32 s87, s91, s86
    s_add_u32 s86, s86, 8192
    s_cmp_ge_u32 s86, 114688
    s_cselect_b32 s86, 0, s86
    buffer_load_dwordx4 v[216:219], v2, s[60:63], s87 offen offset:0 sc1
    s_waitcnt lgkmcnt(8)
    v_mfma_f32_32x32x16_bf16 v[32:47], v[100:103], v[184:187], v[32:47]
    ds_read_b64_tr_b16 v[80:81], v10 offset:18432
    ds_read_b64_tr_b16 v[82:83], v10 offset:19456
    ds_read_b64_tr_b16 v[84:85], v9 offset:18432
    ds_read_b64_tr_b16 v[86:87], v9 offset:19456
    s_waitcnt vmcnt(7)
    s_waitcnt lgkmcnt(10)
    v_mfma_f32_32x32x16_bf16 v[48:63], v[64:67], v[188:191], v[48:63]
    buffer_load_dwordx4 v[220:223], v2, s[60:63], s87 offen offset:1024 sc1
    s_waitcnt lgkmcnt(8)
    v_mfma_f32_32x32x16_bf16 v[32:47], v[68:71], v[188:191], v[32:47]
    ds_read_b64_tr_b16 v[88:89], v10 offset:24576
    ds_read_b64_tr_b16 v[90:91], v10 offset:25600
    ds_read_b64_tr_b16 v[92:93], v9 offset:24576
    ds_read_b64_tr_b16 v[94:95], v9 offset:25600
    s_waitcnt vmcnt(7)
    s_waitcnt lgkmcnt(10)
    v_mfma_f32_32x32x16_bf16 v[48:63], v[72:75], v[192:195], v[48:63]
    s_barrier
    s_add_u32 s87, s91, s86
    s_add_u32 s86, s86, 8192
    s_cmp_ge_u32 s86, 114688
    s_cselect_b32 s86, 0, s86
    buffer_load_dwordx4 v[224:227], v2, s[60:63], s87 offen offset:0 sc1
    s_waitcnt lgkmcnt(8)
    v_mfma_f32_32x32x16_bf16 v[32:47], v[76:79], v[192:195], v[32:47]
    ds_read_b64_tr_b16 v[96:97], v10 offset:26624
    ds_read_b64_tr_b16 v[98:99], v10 offset:27648
    ds_read_b64_tr_b16 v[100:101], v9 offset:26624
    ds_read_b64_tr_b16 v[102:103], v9 offset:27648
    s_waitcnt vmcnt(7)
    s_waitcnt lgkmcnt(10)
    v_mfma_f32_32x32x16_bf16 v[48:63], v[80:83], v[196:199], v[48:63]
    buffer_load_dwordx4 v[228:231], v2, s[60:63], s87 offen offset:1024 sc1
    s_waitcnt lgkmcnt(8)
    v_mfma_f32_32x32x16_bf16 v[32:47], v[84:87], v[196:199], v[32:47]
    ds_read_b64_tr_b16 v[64:65], v10 offset:32768
    ds_read_b64_tr_b16 v[66:67], v10 offset:33792
    ds_read_b64_tr_b16 v[68:69], v9 offset:32768
    ds_read_b64_tr_b16 v[70:71], v9 offset:33792
    s_waitcnt vmcnt(7)
    s_waitcnt lgkmcnt(10)
    v_mfma_f32_32x32x16_bf16 v[48:63], v[88:91], v[200:203], v[48:63]
    s_add_u32 s87, s91, s86
    s_add_u32 s86, s86, 8192
    s_cmp_ge_u32 s86, 114688
    s_cselect_b32 s86, 0, s86
    buffer_load_dwordx4 v[232:235], v2, s[60:63], s87 offen offset:0 sc1
    s_waitcnt lgkmcnt(8)
    v_mfma_f32_32x32x16_bf16 v[32:47], v[92:95], v[200:203], v[32:47]
    ds_read_b64_tr_b16 v[72:73], v10 offset:34816
    ds_read_b64_tr_b16 v[74:75], v10 offset:35840
    ds_read_b64_tr_b16 v[76:77], v9 offset:34816
    ds_read_b64_tr_b16 v[78:79], v9 offset:35840
    s_waitcnt vmcnt(7)
    s_waitcnt lgkmcnt(10)
    v_mfma_f32_32x32x16_bf16 v[48:63], v[96:99], v[204:207], v[48:63]
    buffer_load_dwordx4 v[236:239], v2, s[60:63], s87 offen offset:1024 sc1
    s_waitcnt lgkmcnt(8)
    v_mfma_f32_32x32x16_bf16 v[32:47], v[100:103], v[204:207], v[32:47]
    ds_read_b64_tr_b16 v[80:81], v10 offset:40960
    ds_read_b64_tr_b16 v[82:83], v10 offset:41984
    ds_read_b64_tr_b16 v[84:85], v9 offset:40960
    ds_read_b64_tr_b16 v[86:87], v9 offset:41984
    s_waitcnt vmcnt(7)
    s_waitcnt lgkmcnt(10)
    v_mfma_f32_32x32x16_bf16 v[48:63], v[64:67], v[208:211], v[48:63]
    s_waitcnt lgkmcnt(8)
    v_mfma_f32_32x32x16_bf16 v[32:47], v[68:71], v[208:211], v[32:47]
    ds_read_b64_tr_b16 v[88:89], v10 offset:43008
    ds_read_b64_tr_b16 v[90:91], v10 offset:44032
    ds_read_b64_tr_b16 v[92:93], v9 offset:43008
    ds_read_b64_tr_b16 v[94:95], v9 offset:44032
    s_waitcnt vmcnt(6)
    s_waitcnt lgkmcnt(10)
    v_mfma_f32_32x32x16_bf16 v[48:63], v[72:75], v[212:215], v[48:63]
    s_waitcnt lgkmcnt(8)
    v_mfma_f32_32x32x16_bf16 v[32:47], v[76:79], v[212:215], v[32:47]
    ds_read_b64_tr_b16 v[96:97], v10 offset:49152
    ds_read_b64_tr_b16 v[98:99], v10 offset:50176
    ds_read_b64_tr_b16 v[100:101], v9 offset:49152
    ds_read_b64_tr_b16 v[102:103], v9 offset:50176
    s_waitcnt vmcnt(5)
    s_waitcnt lgkmcnt(10)
    v_mfma_f32_32x32x16_bf16 v[48:63], v[80:83], v[216:219], v[48:63]
    s_waitcnt lgkmcnt(8)
    v_mfma_f32_32x32x16_bf16 v[32:47], v[84:87], v[216:219], v[32:47]
    ds_read_b64_tr_b16 v[64:65], v10 offset:51200
    ds_read_b64_tr_b16 v[66:67], v10 offset:52224
    ds_read_b64_tr_b16 v[68:69], v9 offset:51200
    ds_read_b64_tr_b16 v[70:71], v9 offset:52224
    s_waitcnt vmcnt(4)
    s_waitcnt lgkmcnt(10)
    v_mfma_f32_32x32x16_bf16 v[48:63], v[88:91], v[220:223], v[48:63]
    s_waitcnt lgkmcnt(8)
    v_mfma_f32_32x32x16_bf16 v[32:47], v[92:95], v[220:223], v[32:47]
    ds_read_b64_tr_b16 v[72:73], v10 offset:57344
    ds_read_b64_tr_b16 v[74:75], v10 offset:58368
    ds_read_b64_tr_b16 v[76:77], v9 offset:57344
    ds_read_b64_tr_b16 v[78:79], v9 offset:58368
    s_waitcnt vmcnt(3)
    s_waitcnt lgkmcnt(10)
    v_mfma_f32_32x32x16_bf16 v[48:63], v[96:99], v[224:227], v[48:63]
    s_barrier
    s_add_u32 s87, s91, s86
    s_add_u32 s87, s87, 4096
    s_add_u32 s86, s86, 8192
    s_cmp_ge_u32 s86, 114688
    s_cselect_b32 s86, 0, s86
    buffer_load_dwordx4 v[128:131], v2, s[60:63], s87 offen offset:0 sc1
    buffer_load_dwordx4 v[132:135], v2, s[60:63], s87 offen offset:1024 sc1
    s_add_u32 s87, s91, s86
    s_add_u32 s87, s87, 4096
    s_add_u32 s86, s86, 8192
    s_cmp_ge_u32 s86, 114688
    s_cselect_b32 s86, 0, s86
    buffer_load_dwordx4 v[136:139], v2, s[60:63], s87 offen offset:0 sc1
    s_waitcnt lgkmcnt(8)
    v_mfma_f32_32x32x16_bf16 v[32:47], v[100:103], v[224:227], v[32:47]
    ds_read_b64_tr_b16 v[80:81], v10 offset:59392
    ds_read_b64_tr_b16 v[82:83], v10 offset:60416
    ds_read_b64_tr_b16 v[84:85], v9 offset:59392
    ds_read_b64_tr_b16 v[86:87], v9 offset:60416
    s_waitcnt vmcnt(5)
    s_waitcnt lgkmcnt(10)
    v_mfma_f32_32x32x16_bf16 v[48:63], v[64:67], v[228:231], v[48:63]
    buffer_load_dwordx4 v[140:143], v2, s[60:63], s87 offen offset:1024 sc1
    s_add_u32 s87, s91, s86
    s_add_u32 s87, s87, 4096
    s_add_u32 s86, s86, 8192
    s_cmp_ge_u32 s86, 114688
    s_cselect_b32 s86, 0, s86
    buffer_load_dwordx4 v[144:147], v2, s[60:63], s87 offen offset:0 sc1
    buffer_load_dwordx4 v[148:151], v2, s[60:63], s87 offen offset:1024 sc1
    s_waitcnt lgkmcnt(8)
    v_mfma_f32_32x32x16_bf16 v[32:47], v[68:71], v[228:231], v[32:47]
    v_add_u32 v9, 65536, v9
    v_add_u32 v10, 65536, v10
    ds_read_b64_tr_b16 v[88:89], v10 offset:0
    ds_read_b64_tr_b16 v[90:91], v10 offset:1024
    ds_read_b64_tr_b16 v[92:93], v9 offset:0
    ds_read_b64_tr_b16 v[94:95], v9 offset:1024
    s_waitcnt vmcnt(7)
    s_waitcnt lgkmcnt(10)
    v_mfma_f32_32x32x16_bf16 v[48:63], v[72:75], v[232:235], v[48:63]
    s_add_u32 s87, s91, s86
    s_add_u32 s87, s87, 4096
    s_add_u32 s86, s86, 8192
    s_cmp_ge_u32 s86, 114688
    s_cselect_b32 s86, 0, s86
    buffer_load_dwordx4 v[152:155], v2, s[60:63], s87 offen offset:0 sc1
    s_waitcnt lgkmcnt(8)
    v_mfma_f32_32x32x16_bf16 v[32:47], v[76:79], v[232:235], v[32:47]
    ds_read_b64_tr_b16 v[96:97], v10 offset:2048
    ds_read_b64_tr_b16 v[98:99], v10 offset:3072
    ds_read_b64_tr_b16 v[100:101], v9 offset:2048
    ds_read_b64_tr_b16 v[102:103], v9 offset:3072
    s_waitcnt vmcnt(7)
    s_waitcnt lgkmcnt(10)
    v_mfma_f32_32x32x16_bf16 v[48:63], v[80:83], v[236:239], v[48:63]
    buffer_load_dwordx4 v[156:159], v2, s[60:63], s87 offen offset:1024 sc1
    s_waitcnt lgkmcnt(8)
    v_mfma_f32_32x32x16_bf16 v[32:47], v[84:87], v[236:239], v[32:47]
    v_subrev_u32 v9, 131072, v9
    v_subrev_u32 v10, 131072, v10
    ds_read_b64_tr_b16 v[64:65], v10 offset:0
    ds_read_b64_tr_b16 v[66:67], v10 offset:1024
    ds_read_b64_tr_b16 v[68:69], v9 offset:0
    ds_read_b64_tr_b16 v[70:71], v9 offset:1024
    s_waitcnt vmcnt(7)
    s_waitcnt lgkmcnt(10)
    v_mfma_f32_32x32x16_bf16 v[48:63], v[88:91], v[128:131], v[48:63]
    s_add_u32 s87, s91, s86
    s_add_u32 s87, s87, 4096
    s_add_u32 s86, s86, 8192
    s_cmp_ge_u32 s86, 114688
    s_cselect_b32 s86, 0, s86
    buffer_load_dwordx4 v[160:163], v2, s[60:63], s87 offen offset:0 sc1
    s_waitcnt lgkmcnt(8)
    v_mfma_f32_32x32x16_bf16 v[32:47], v[92:95], v[128:131], v[32:47]
    ds_read_b64_tr_b16 v[72:73], v10 offset:2048
    ds_read_b64_tr_b16 v[74:75], v10 offset:3072
    ds_read_b64_tr_b16 v[76:77], v9 offset:2048
    ds_read_b64_tr_b16 v[78:79], v9 offset:3072
    s_waitcnt vmcnt(7)
    s_waitcnt lgkmcnt(10)
    v_mfma_f32_32x32x16_bf16 v[48:63], v[96:99], v[132:135], v[48:63]
    buffer_load_dwordx4 v[164:167], v2, s[60:63], s87 offen offset:1024 sc1
    s_waitcnt lgkmcnt(8)
    v_mfma_f32_32x32x16_bf16 v[32:47], v[100:103], v[132:135], v[32:47]
    ds_read_b64_tr_b16 v[80:81], v10 offset:8192
    ds_read_b64_tr_b16 v[82:83], v10 offset:9216
    ds_read_b64_tr_b16 v[84:85], v9 offset:8192
    ds_read_b64_tr_b16 v[86:87], v9 offset:9216
    s_waitcnt vmcnt(7)
    s_waitcnt lgkmcnt(10)
    v_mfma_f32_32x32x16_bf16 v[48:63], v[64:67], v[136:139], v[48:63]
    s_add_u32 s87, s91, s86
    s_add_u32 s87, s87, 4096
    s_add_u32 s86, s86, 8192
    s_cmp_ge_u32 s86, 114688
    s_cselect_b32 s86, 0, s86
    buffer_load_dwordx4 v[168:171], v2, s[60:63], s87 offen offset:0 sc1
    s_waitcnt lgkmcnt(8)
    v_mfma_f32_32x32x16_bf16 v[32:47], v[68:71], v[136:139], v[32:47]
    ds_read_b64_tr_b16 v[88:89], v10 offset:10240
    ds_read_b64_tr_b16 v[90:91], v10 offset:11264
    ds_read_b64_tr_b16 v[92:93], v9 offset:10240
    ds_read_b64_tr_b16 v[94:95], v9 offset:11264
    s_waitcnt vmcnt(7)
    s_waitcnt lgkmcnt(10)
    v_mfma_f32_32x32x16_bf16 v[48:63], v[72:75], v[140:143], v[48:63]
    buffer_load_dwordx4 v[172:175], v2, s[60:63], s87 offen offset:1024 sc1
    s_waitcnt lgkmcnt(8)
    v_mfma_f32_32x32x16_bf16 v[32:47], v[76:79], v[140:143], v[32:47]
    ds_read_b64_tr_b16 v[96:97], v10 offset:16384
    ds_read_b64_tr_b16 v[98:99], v10 offset:17408
    ds_read_b64_tr_b16 v[100:101], v9 offset:16384
    ds_read_b64_tr_b16 v[102:103], v9 offset:17408
    s_waitcnt vmcnt(7)
    s_waitcnt lgkmcnt(10)
    v_mfma_f32_32x32x16_bf16 v[48:63], v[80:83], v[144:147], v[48:63]
    s_barrier
    s_add_u32 s87, s91, s86
    s_add_u32 s87, s87, 4096
    s_add_u32 s86, s86, 8192
    s_cmp_ge_u32 s86, 114688
    s_cselect_b32 s86, 0, s86
    buffer_load_dwordx4 v[176:179], v2, s[60:63], s87 offen offset:0 sc1
    s_waitcnt lgkmcnt(8)
    v_mfma_f32_32x32x16_bf16 v[32:47], v[84:87], v[144:147], v[32:47]
    ds_read_b64_tr_b16 v[64:65], v10 offset:18432
    ds_read_b64_tr_b16 v[66:67], v10 offset:19456
    ds_read_b64_tr_b16 v[68:69], v9 offset:18432
    ds_read_b64_tr_b16 v[70:71], v9 offset:19456
    s_waitcnt vmcnt(7)
    s_waitcnt lgkmcnt(10)
    v_mfma_f32_32x32x16_bf16 v[48:63], v[88:91], v[148:151], v[48:63]
    buffer_load_dwordx4 v[180:183], v2, s[60:63], s87 offen offset:1024 sc1
    s_waitcnt lgkmcnt(8)
    v_mfma_f32_32x32x16_bf16 v[32:47], v[92:95], v[148:151], v[32:47]
    ds_read_b64_tr_b16 v[72:73], v10 offset:24576
    ds_read_b64_tr_b16 v[74:75], v10 offset:25600
    ds_read_b64_tr_b16 v[76:77], v9 offset:24576
    ds_read_b64_tr_b16 v[78:79], v9 offset:25600
    s_waitcnt vmcnt(7)
    s_waitcnt lgkmcnt(10)
    v_mfma_f32_32x32x16_bf16 v[48:63], v[96:99], v[152:155], v[48:63]
    s_add_u32 s87, s91, s86
    s_add_u32 s87, s87, 4096
    s_add_u32 s86, s86, 8192
    s_cmp_ge_u32 s86, 114688
    s_cselect_b32 s86, 0, s86
    buffer_load_dwordx4 v[184:187], v2, s[60:63], s87 offen offset:0 sc1
    s_waitcnt lgkmcnt(8)
    v_mfma_f32_32x32x16_bf16 v[32:47], v[100:103], v[152:155], v[32:47]
    ds_read_b64_tr_b16 v[80:81], v10 offset:26624
    ds_read_b64_tr_b16 v[82:83], v10 offset:27648
    ds_read_b64_tr_b16 v[84:85], v9 offset:26624
    ds_read_b64_tr_b16 v[86:87], v9 offset:27648
    s_waitcnt vmcnt(7)
    s_waitcnt lgkmcnt(10)
    v_mfma_f32_32x32x16_bf16 v[48:63], v[64:67], v[156:159], v[48:63]
    buffer_load_dwordx4 v[188:191], v2, s[60:63], s87 offen offset:1024 sc1
    s_waitcnt lgkmcnt(8)
    v_mfma_f32_32x32x16_bf16 v[32:47], v[68:71], v[156:159], v[32:47]
    ds_read_b64_tr_b16 v[88:89], v10 offset:32768
    ds_read_b64_tr_b16 v[90:91], v10 offset:33792
    ds_read_b64_tr_b16 v[92:93], v9 offset:32768
    ds_read_b64_tr_b16 v[94:95], v9 offset:33792
    s_waitcnt vmcnt(7)
    s_waitcnt lgkmcnt(10)
    v_mfma_f32_32x32x16_bf16 v[48:63], v[72:75], v[160:163], v[48:63]
    s_add_u32 s87, s91, s86
    s_add_u32 s87, s87, 4096
    s_add_u32 s86, s86, 8192
    s_cmp_ge_u32 s86, 114688
    s_cselect_b32 s86, 0, s86
    buffer_load_dwordx4 v[192:195], v2, s[60:63], s87 offen offset:0 sc1
    s_waitcnt lgkmcnt(8)
    v_mfma_f32_32x32x16_bf16 v[32:47], v[76:79], v[160:163], v[32:47]
    ds_read_b64_tr_b16 v[96:97], v10 offset:34816
    ds_read_b64_tr_b16 v[98:99], v10 offset:35840
    ds_read_b64_tr_b16 v[100:101], v9 offset:34816
    ds_read_b64_tr_b16 v[102:103], v9 offset:35840
    s_waitcnt vmcnt(7)
    s_waitcnt lgkmcnt(10)
    v_mfma_f32_32x32x16_bf16 v[48:63], v[80:83], v[164:167], v[48:63]
    buffer_load_dwordx4 v[196:199], v2, s[60:63], s87 offen offset:1024 sc1
    s_waitcnt lgkmcnt(8)
    v_mfma_f32_32x32x16_bf16 v[32:47], v[84:87], v[164:167], v[32:47]
    ds_read_b64_tr_b16 v[64:65], v10 offset:40960
    ds_read_b64_tr_b16 v[66:67], v10 offset:41984
    ds_read_b64_tr_b16 v[68:69], v9 offset:40960
    ds_read_b64_tr_b16 v[70:71], v9 offset:41984
    s_waitcnt vmcnt(7)
    s_waitcnt lgkmcnt(10)
    v_mfma_f32_32x32x16_bf16 v[48:63], v[88:91], v[168:171], v[48:63]
    s_add_u32 s87, s91, s86
    s_add_u32 s87, s87, 4096
    s_add_u32 s86, s86, 8192
    s_cmp_ge_u32 s86, 114688
    s_cselect_b32 s86, 0, s86
    buffer_load_dwordx4 v[200:203], v2, s[60:63], s87 offen offset:0 sc1
    s_waitcnt lgkmcnt(8)
    v_mfma_f32_32x32x16_bf16 v[32:47], v[92:95], v[168:171], v[32:47]
    ds_read_b64_tr_b16 v[72:73], v10 offset:43008
    ds_read_b64_tr_b16 v[74:75], v10 offset:44032
    ds_read_b64_tr_b16 v[76:77], v9 offset:43008
    ds_read_b64_tr_b16 v[78:79], v9 offset:44032
    s_waitcnt vmcnt(7)
    s_waitcnt lgkmcnt(10)
    v_mfma_f32_32x32x16_bf16 v[48:63], v[96:99], v[172:175], v[48:63]
    buffer_load_dwordx4 v[204:207], v2, s[60:63], s87 offen offset:1024 sc1
    s_waitcnt lgkmcnt(8)
    v_mfma_f32_32x32x16_bf16 v[32:47], v[100:103], v[172:175], v[32:47]
    ds_read_b64_tr_b16 v[80:81], v10 offset:49152
    ds_read_b64_tr_b16 v[82:83], v10 offset:50176
    ds_read_b64_tr_b16 v[84:85], v9 offset:49152
    ds_read_b64_tr_b16 v[86:87], v9 offset:50176
    s_waitcnt vmcnt(7)
    s_waitcnt lgkmcnt(10)
    v_mfma_f32_32x32x16_bf16 v[48:63], v[64:67], v[176:179], v[48:63]
    s_barrier
    s_add_u32 s87, s91, s86
    s_add_u32 s87, s87, 4096
    s_add_u32 s86, s86, 8192
    s_cmp_ge_u32 s86, 114688
    s_cselect_b32 s86, 0, s86
    buffer_load_dwordx4 v[208:211], v2, s[60:63], s87 offen offset:0 sc1
    s_waitcnt lgkmcnt(8)
    v_mfma_f32_32x32x16_bf16 v[32:47], v[68:71], v[176:179], v[32:47]
    ds_read_b64_tr_b16 v[88:89], v10 offset:51200
    ds_read_b64_tr_b16 v[90:91], v10 offset:52224
    ds_read_b64_tr_b16 v[92:93], v9 offset:51200
    ds_read_b64_tr_b16 v[94:95], v9 offset:52224
    s_waitcnt vmcnt(7)
    s_waitcnt lgkmcnt(10)
    v_mfma_f32_32x32x16_bf16 v[48:63], v[72:75], v[180:183], v[48:63]
    buffer_load_dwordx4 v[212:215], v2, s[60:63], s87 offen offset:1024 sc1
    s_waitcnt lgkmcnt(8)
    v_mfma_f32_32x32x16_bf16 v[32:47], v[76:79], v[180:183], v[32:47]
    ds_read_b64_tr_b16 v[96:97], v10 offset:57344
    ds_read_b64_tr_b16 v[98:99], v10 offset:58368
    ds_read_b64_tr_b16 v[100:101], v9 offset:57344
    ds_read_b64_tr_b16 v[102:103], v9 offset:58368
    s_waitcnt vmcnt(7)
    s_waitcnt lgkmcnt(10)
    v_mfma_f32_32x32x16_bf16 v[48:63], v[80:83], v[184:187], v[48:63]
    s_add_u32 s87, s91, s86
    s_add_u32 s87, s87, 4096
    s_add_u32 s86, s86, 8192
    s_cmp_ge_u32 s86, 114688
    s_cselect_b32 s86, 0, s86
    buffer_load_dwordx4 v[216:219], v2, s[60:63], s87 offen offset:0 sc1
    s_waitcnt lgkmcnt(8)
    v_mfma_f32_32x32x16_bf16 v[32:47], v[84:87], v[184:187], v[32:47]
    ds_read_b64_tr_b16 v[64:65], v10 offset:59392
    ds_read_b64_tr_b16 v[66:67], v10 offset:60416
    ds_read_b64_tr_b16 v[68:69], v9 offset:59392
    ds_read_b64_tr_b16 v[70:71], v9 offset:60416
    s_waitcnt vmcnt(7)
    s_waitcnt lgkmcnt(10)
    v_mfma_f32_32x32x16_bf16 v[48:63], v[88:91], v[188:191], v[48:63]
    buffer_load_dwordx4 v[220:223], v2, s[60:63], s87 offen offset:1024 sc1
    s_waitcnt lgkmcnt(8)
    v_mfma_f32_32x32x16_bf16 v[32:47], v[92:95], v[188:191], v[32:47]
    v_add_u32 v9, 131072, v9
    v_add_u32 v10, 131072, v10
    ds_read_b64_tr_b16 v[72:73], v10 offset:8192
    ds_read_b64_tr_b16 v[74:75], v10 offset:9216
    ds_read_b64_tr_b16 v[76:77], v9 offset:8192
    ds_read_b64_tr_b16 v[78:79], v9 offset:9216
    s_waitcnt vmcnt(7)
    s_waitcnt lgkmcnt(10)
    v_mfma_f32_32x32x16_bf16 v[48:63], v[96:99], v[192:195], v[48:63]
    s_add_u32 s87, s91, s86
    s_add_u32 s87, s87, 4096
    s_add_u32 s86, s86, 8192
    s_cmp_ge_u32 s86, 114688
    s_cselect_b32 s86, 0, s86
    buffer_load_dwordx4 v[224:227], v2, s[60:63], s87 offen offset:0 sc1
    s_waitcnt lgkmcnt(8)
    v_mfma_f32_32x32x16_bf16 v[32:47], v[100:103], v[192:195], v[32:47]
    ds_read_b64_tr_b16 v[80:81], v10 offset:10240
    ds_read_b64_tr_b16 v[82:83], v10 offset:11264
    ds_read_b64_tr_b16 v[84:85], v9 offset:10240
    ds_read_b64_tr_b16 v[86:87], v9 offset:11264
    s_waitcnt vmcnt(7)
    s_waitcnt lgkmcnt(10)
    v_mfma_f32_32x32x16_bf16 v[48:63], v[64:67], v[196:199], v[48:63]
    buffer_load_dwordx4 v[228:231], v2, s[60:63], s87 offen offset:1024 sc1
    s_waitcnt lgkmcnt(8)
    v_mfma_f32_32x32x16_bf16 v[32:47], v[68:71], v[196:199], v[32:47]
    ds_read_b64_tr_b16 v[88:89], v10 offset:16384
    ds_read_b64_tr_b16 v[90:91], v10 offset:17408
    ds_read_b64_tr_b16 v[92:93], v9 offset:16384
    ds_read_b64_tr_b16 v[94:95], v9 offset:17408
    s_waitcnt vmcnt(7)
    s_waitcnt lgkmcnt(10)
    v_mfma_f32_32x32x16_bf16 v[48:63], v[72:75], v[200:203], v[48:63]
    s_add_u32 s87, s91, s86
    s_add_u32 s87, s87, 4096
    s_add_u32 s86, s86, 8192
    s_cmp_ge_u32 s86, 114688
    s_cselect_b32 s86, 0, s86
    buffer_load_dwordx4 v[232:235], v2, s[60:63], s87 offen offset:0 sc1
    s_waitcnt lgkmcnt(8)
    v_mfma_f32_32x32x16_bf16 v[32:47], v[76:79], v[200:203], v[32:47]
    ds_read_b64_tr_b16 v[96:97], v10 offset:18432
    ds_read_b64_tr_b16 v[98:99], v10 offset:19456
    ds_read_b64_tr_b16 v[100:101], v9 offset:18432
    ds_read_b64_tr_b16 v[102:103], v9 offset:19456
    s_waitcnt vmcnt(7)
    s_waitcnt lgkmcnt(10)
    v_mfma_f32_32x32x16_bf16 v[48:63], v[80:83], v[204:207], v[48:63]
    buffer_load_dwordx4 v[236:239], v2, s[60:63], s87 offen offset:1024 sc1
    s_waitcnt lgkmcnt(8)
    v_mfma_f32_32x32x16_bf16 v[32:47], v[84:87], v[204:207], v[32:47]
    v_subrev_u32 v9, 65536, v9
    v_subrev_u32 v10, 65536, v10
    ds_read_b64_tr_b16 v[64:65], v10 offset:0
    ds_read_b64_tr_b16 v[66:67], v10 offset:1024
    ds_read_b64_tr_b16 v[68:69], v9 offset:0
    ds_read_b64_tr_b16 v[70:71], v9 offset:1024
    s_waitcnt vmcnt(7)
    s_waitcnt lgkmcnt(10)
    v_mfma_f32_32x32x16_bf16 v[48:63], v[88:91], v[208:211], v[48:63]
    s_barrier
    s_waitcnt lgkmcnt(8)
    v_mfma_f32_32x32x16_bf16 v[32:47], v[92:95], v[208:211], v[32:47]
    ds_read_b64_tr_b16 v[72:73], v10 offset:2048
    ds_read_b64_tr_b16 v[74:75], v10 offset:3072
    ds_read_b64_tr_b16 v[76:77], v9 offset:2048
    ds_read_b64_tr_b16 v[78:79], v9 offset:3072
    s_waitcnt vmcnt(6)
    s_waitcnt lgkmcnt(10)
    v_mfma_f32_32x32x16_bf16 v[48:63], v[96:99], v[212:215], v[48:63]
    s_waitcnt lgkmcnt(8)
    v_mfma_f32_32x32x16_bf16 v[32:47], v[100:103], v[212:215], v[32:47]
    ds_read_b64_tr_b16 v[80:81], v10 offset:8192
    ds_read_b64_tr_b16 v[82:83], v10 offset:9216
    ds_read_b64_tr_b16 v[84:85], v9 offset:8192
    ds_read_b64_tr_b16 v[86:87], v9 offset:9216
    s_waitcnt vmcnt(5)
    s_waitcnt lgkmcnt(10)
    v_mfma_f32_32x32x16_bf16 v[48:63], v[64:67], v[216:219], v[48:63]
    s_waitcnt lgkmcnt(8)
    v_mfma_f32_32x32x16_bf16 v[32:47], v[68:71], v[216:219], v[32:47]
    ds_read_b64_tr_b16 v[88:89], v10 offset:10240
    ds_read_b64_tr_b16 v[90:91], v10 offset:11264
    ds_read_b64_tr_b16 v[92:93], v9 offset:10240
    ds_read_b64_tr_b16 v[94:95], v9 offset:11264
    s_waitcnt vmcnt(4)
    s_waitcnt lgkmcnt(10)
    v_mfma_f32_32x32x16_bf16 v[48:63], v[72:75], v[220:223], v[48:63]
    s_waitcnt lgkmcnt(8)
    v_mfma_f32_32x32x16_bf16 v[32:47], v[76:79], v[220:223], v[32:47]
    ds_read_b64_tr_b16 v[96:97], v10 offset:16384
    ds_read_b64_tr_b16 v[98:99], v10 offset:17408
    ds_read_b64_tr_b16 v[100:101], v9 offset:16384
    ds_read_b64_tr_b16 v[102:103], v9 offset:17408
    s_waitcnt vmcnt(3)
    s_waitcnt lgkmcnt(10)
    v_mfma_f32_32x32x16_bf16 v[48:63], v[80:83], v[224:227], v[48:63]
    s_waitcnt lgkmcnt(8)
    v_mfma_f32_32x32x16_bf16 v[32:47], v[84:87], v[224:227], v[32:47]
    ds_read_b64_tr_b16 v[64:65], v10 offset:18432
    ds_read_b64_tr_b16 v[66:67], v10 offset:19456
    ds_read_b64_tr_b16 v[68:69], v9 offset:18432
    ds_read_b64_tr_b16 v[70:71], v9 offset:19456
    s_waitcnt vmcnt(2)
    s_waitcnt lgkmcnt(10)
    v_mfma_f32_32x32x16_bf16 v[48:63], v[88:91], v[228:231], v[48:63]
    s_waitcnt lgkmcnt(8)
    v_mfma_f32_32x32x16_bf16 v[32:47], v[92:95], v[228:231], v[32:47]
    s_waitcnt vmcnt(1)
    s_waitcnt lgkmcnt(6)
    v_mfma_f32_32x32x16_bf16 v[48:63], v[96:99], v[232:235], v[48:63]
    s_waitcnt vmcnt(0)
    s_waitcnt lgkmcnt(2)
    v_mfma_f32_32x32x16_bf16 v[48:63], v[64:67], v[236:239], v[48:63]
    v_mfma_f32_32x32x16_bf16 v[32:47], v[100:103], v[232:235], v[32:47]
    s_waitcnt lgkmcnt(0)
    v_mfma_f32_32x32x16_bf16 v[32:47], v[68:71], v[236:239], v[32:47]
    s_lshl_b32 s76, s3, 12
    s_add_u32 s76, s76, 16384
    s_xor_b32 s77, s76, 8192
    v_add_u32 v10, s76, v8
    v_add_u32 v13, s77, v8
    v_lshlrev_b32 v160, 16, v16
    v_and_b32 v161, 0xffff0000, v16
    v_lshlrev_b32 v162, 16, v17
    v_and_b32 v163, 0xffff0000, v17
    v_lshlrev_b32 v164, 16, v18
    v_and_b32 v165, 0xffff0000, v18
    v_lshlrev_b32 v166, 16, v19
    v_and_b32 v167, 0xffff0000, v19
    v_lshlrev_b32 v168, 16, v20
    v_and_b32 v169, 0xffff0000, v20
    v_lshlrev_b32 v170, 16, v21
    v_and_b32 v171, 0xffff0000, v21
    v_lshlrev_b32 v172, 16, v22
    v_and_b32 v173, 0xffff0000, v22
    v_lshlrev_b32 v174, 16, v23
    v_and_b32 v175, 0xffff0000, v23
    ds_write_b128 v10, v[48:51] offset:0
    ds_write_b128 v10, v[52:55] offset:1024
    ds_write_b128 v10, v[56:59] offset:2048
    ds_write_b128 v10, v[60:63] offset:3072
    s_waitcnt lgkmcnt(0)
    s_barrier
    ds_read_b128 v[144:147], v13 offset:0
    ds_read_b128 v[148:151], v13 offset:1024
    ds_read_b128 v[152:155], v13 offset:2048
    ds_read_b128 v[156:159], v13 offset:3072
    s_waitcnt lgkmcnt(2)
    v_pk_add_f32 v[144:145], v[144:145], v[32:33]
    v_pk_add_f32 v[146:147], v[146:147], v[34:35]
    v_pk_add_f32 v[148:149], v[148:149], v[36:37]
    v_pk_add_f32 v[150:151], v[150:151], v[38:39]
    v_pk_fma_f32 v[160:161], v[112:113], v[144:145], v[160:161]
    v_pk_fma_f32 v[162:163], v[114:115], v[146:147], v[162:163]
    v_pk_fma_f32 v[164:165], v[116:117], v[148:149], v[164:165]
    v_pk_fma_f32 v[166:167], v[118:119], v[150:151], v[166:167]
    v_cvt_pk_bf16_f32 v24, v160, v161
    v_cvt_pk_bf16_f32 v25, v162, v163
    v_cvt_pk_bf16_f32 v26, v164, v165
    v_cvt_pk_bf16_f32 v27, v166, v167
    s_nop 1
    v_permlane32_swap_b32 v24, v26
    v_permlane32_swap_b32 v25, v27
    buffer_store_dwordx4 v[24:27], v11, s[64:67], 0 offen offset:0
    s_waitcnt lgkmcnt(0)
    v_pk_add_f32 v[152:153], v[152:153], v[40:41]
    v_pk_add_f32 v[154:155], v[154:155], v[42:43]
    v_pk_add_f32 v[156:157], v[156:157], v[44:45]
    v_pk_add_f32 v[158:159], v[158:159], v[46:47]
    v_pk_fma_f32 v[168:169], v[120:121], v[152:153], v[168:169]
    v_pk_fma_f32 v[170:171], v[122:123], v[154:155], v[170:171]
    v_pk_fma_f32 v[172:173], v[124:125], v[156:157], v[172:173]
    v_pk_fma_f32 v[174:175], v[126:127], v[158:159], v[174:175]
    v_cvt_pk_bf16_f32 v28, v168, v169
    v_cvt_pk_bf16_f32 v29, v170, v171
    v_cvt_pk_bf16_f32 v30, v172, v173
    v_cvt_pk_bf16_f32 v31, v174, v175
    s_nop 1
    v_permlane32_swap_b32 v28, v30
    v_permlane32_swap_b32 v29, v31
    buffer_store_dwordx4 v[28:31], v11, s[64:67], 0 offen offset:32
    s_branch L_fin
L_p3s:
    s_cmp_eq_u32 s3, 1
    s_cbranch_scc0 L_s1
    v_mov_b32 v24, v25
L_s1:
    s_cmp_eq_u32 s3, 2
    s_cbranch_scc0 L_s2
    v_mov_b32 v24, v26
L_s2:
    s_cmp_eq_u32 s3, 3
    s_cbranch_scc0 L_s3
    v_mov_b32 v24, v27
L_s3:
    v_and_b32 v13, 1, v1
    v_lshlrev_b32 v13, 10, v13
    v_lshrrev_b32 v15, 5, v1
    v_lshl_add_u32 v13, v15, 4, v13
    s_barrier
    v_add_u32 v24, 65536, v24
    ds_read_b64_tr_b16 v[96:97], v24 offset:0
    ds_read_b64_tr_b16 v[98:99], v24 offset:1024
    ds_read_b128 v[100:103], v13 offset:0
    ds_read_b64_tr_b16 v[104:105], v24 offset:2048
    ds_read_b64_tr_b16 v[106:107], v24 offset:3072
    ds_read_b128 v[108:111], v13 offset:32
    ds_read_b64_tr_b16 v[112:113], v24 offset:8192
    ds_read_b64_tr_b16 v[114:115], v24 offset:9216
    ds_read_b128 v[116:119], v13 offset:64
    ds_read_b64_tr_b16 v[120:121], v24 offset:10240
    ds_read_b64_tr_b16 v[122:123], v24 offset:11264
    ds_read_b128 v[124:127], v13 offset:96
    s_waitcnt lgkmcnt(9)
    v_mfma_f32_32x32x16_bf16 v[64:79], v[96:99], v[100:103], 0
    ds_read_b64_tr_b16 v[128:129], v24 offset:16384
    ds_read_b64_tr_b16 v[130:131], v24 offset:17408
    ds_read_b128 v[132:135], v13 offset:128
    s_waitcnt lgkmcnt(9)
    v_mfma_f32_32x32x16_bf16 v[64:79], v[104:107], v[108:111], v[64:79]
    ds_read_b64_tr_b16 v[96:97], v24 offset:18432
    ds_read_b64_tr_b16 v[98:99], v24 offset:19456
    ds_read_b128 v[100:103], v13 offset:160
    s_waitcnt lgkmcnt(9)
    v_mfma_f32_32x32x16_bf16 v[64:79], v[112:115], v[116:119], v[64:79]
    ds_read_b64_tr_b16 v[104:105], v24 offset:24576
    ds_read_b64_tr_b16 v[106:107], v24 offset:25600
    ds_read_b128 v[108:111], v13 offset:192
    s_waitcnt lgkmcnt(9)
    v_mfma_f32_32x32x16_bf16 v[64:79], v[120:123], v[124:127], v[64:79]
    ds_read_b64_tr_b16 v[112:113], v24 offset:26624
    ds_read_b64_tr_b16 v[114:115], v24 offset:27648
    ds_read_b128 v[116:119], v13 offset:224
    s_waitcnt lgkmcnt(9)
    v_mfma_f32_32x32x16_bf16 v[64:79], v[128:131], v[132:135], v[64:79]
    ds_read_b64_tr_b16 v[120:121], v24 offset:32768
    ds_read_b64_tr_b16 v[122:123], v24 offset:33792
    ds_read_b128 v[124:127], v13 offset:256
    s_waitcnt lgkmcnt(9)
    v_mfma_f32_32x32x16_bf16 v[64:79], v[96:99], v[100:103], v[64:79]
    ds_read_b64_tr_b16 v[128:129], v24 offset:34816
    ds_read_b64_tr_b16 v[130:131], v24 offset:35840
    ds_read_b128 v[132:135], v13 offset:288
    s_waitcnt lgkmcnt(9)
    v_mfma_f32_32x32x16_bf16 v[64:79], v[104:107], v[108:111], v[64:79]
    ds_read_b64_tr_b16 v[96:97], v24 offset:40960
    ds_read_b64_tr_b16 v[98:99], v24 offset:41984
    ds_read_b128 v[100:103], v13 offset:320
    s_waitcnt lgkmcnt(9)
    v_mfma_f32_32x32x16_bf16 v[64:79], v[112:115], v[116:119], v[64:79]
    ds_read_b64_tr_b16 v[104:105], v24 offset:43008
    ds_read_b64_tr_b16 v[106:107], v24 offset:44032
    ds_read_b128 v[108:111], v13 offset:352
    s_waitcnt lgkmcnt(9)
    v_mfma_f32_32x32x16_bf16 v[64:79], v[120:123], v[124:127], v[64:79]
    ds_read_b64_tr_b16 v[112:113], v24 offset:49152
    ds_read_b64_tr_b16 v[114:115], v24 offset:50176
    ds_read_b128 v[116:119], v13 offset:384
    s_waitcnt lgkmcnt(9)
    v_mfma_f32_32x32x16_bf16 v[64:79], v[128:131], v[132:135], v[64:79]
    ds_read_b64_tr_b16 v[120:121], v24 offset:51200
    ds_read_b64_tr_b16 v[122:123], v24 offset:52224
    ds_read_b128 v[124:127], v13 offset:416
    s_waitcnt lgkmcnt(9)
    v_mfma_f32_32x32x16_bf16 v[64:79], v[96:99], v[100:103], v[64:79]
    ds_read_b64_tr_b16 v[128:129], v24 offset:57344
    ds_read_b64_tr_b16 v[130:131], v24 offset:58368
    ds_read_b128 v[132:135], v13 offset:448
    s_waitcnt lgkmcnt(9)
    v_mfma_f32_32x32x16_bf16 v[64:79], v[104:107], v[108:111], v[64:79]
    ds_read_b64_tr_b16 v[96:97], v24 offset:59392
    ds_read_b64_tr_b16 v[98:99], v24 offset:60416
    ds_read_b128 v[100:103], v13 offset:480
    s_waitcnt lgkmcnt(9)
    v_mfma_f32_32x32x16_bf16 v[64:79], v[112:115], v[116:119], v[64:79]
    v_add_u32 v24, 65536, v24
    ds_read_b64_tr_b16 v[104:105], v24 offset:0
    ds_read_b64_tr_b16 v[106:107], v24 offset:1024
    ds_read_b128 v[108:111], v13 offset:512
    s_waitcnt lgkmcnt(9)
    v_mfma_f32_32x32x16_bf16 v[64:79], v[120:123], v[124:127], v[64:79]
    ds_read_b64_tr_b16 v[112:113], v24 offset:2048
    ds_read_b64_tr_b16 v[114:115], v24 offset:3072
    ds_read_b128 v[116:119], v13 offset:544
    s_waitcnt lgkmcnt(9)
    v_mfma_f32_32x32x16_bf16 v[64:79], v[128:131], v[132:135], v[64:79]
    v_subrev_u32 v24, 131072, v24
    ds_read_b64_tr_b16 v[120:121], v24 offset:0
    ds_read_b64_tr_b16 v[122:123], v24 offset:1024
    ds_read_b128 v[124:127], v13 offset:576
    s_waitcnt lgkmcnt(9)
    v_mfma_f32_32x32x16_bf16 v[64:79], v[96:99], v[100:103], v[64:79]
    ds_read_b64_tr_b16 v[128:129], v24 offset:2048
    ds_read_b64_tr_b16 v[130:131], v24 offset:3072
    ds_read_b128 v[132:135], v13 offset:608
    s_waitcnt lgkmcnt(9)
    v_mfma_f32_32x32x16_bf16 v[64:79], v[104:107], v[108:111], v[64:79]
    ds_read_b64_tr_b16 v[96:97], v24 offset:8192
    ds_read_b64_tr_b16 v[98:99], v24 offset:9216
    ds_read_b128 v[100:103], v13 offset:640
    s_waitcnt lgkmcnt(9)
    v_mfma_f32_32x32x16_bf16 v[64:79], v[112:115], v[116:119], v[64:79]
    ds_read_b64_tr_b16 v[104:105], v24 offset:10240
    ds_read_b64_tr_b16 v[106:107], v24 offset:11264
    ds_read_b128 v[108:111], v13 offset:672
    s_waitcnt lgkmcnt(9)
    v_mfma_f32_32x32x16_bf16 v[64:79], v[120:123], v[124:127], v[64:79]
    ds_read_b64_tr_b16 v[112:113], v24 offset:16384
    ds_read_b64_tr_b16 v[114:115], v24 offset:17408
    ds_read_b128 v[116:119], v13 offset:704
    s_waitcnt lgkmcnt(9)
    v_mfma_f32_32x32x16_bf16 v[64:79], v[128:131], v[132:135], v[64:79]
    ds_read_b64_tr_b16 v[120:121], v24 offset:18432
    ds_read_b64_tr_b16 v[122:123], v24 offset:19456
    ds_read_b128 v[124:127], v13 offset:736
    s_waitcnt lgkmcnt(9)
    v_mfma_f32_32x32x16_bf16 v[64:79], v[96:99], v[100:103], v[64:79]
    ds_read_b64_tr_b16 v[128:129], v24 offset:24576
    ds_read_b64_tr_b16 v[130:131], v24 offset:25600
    ds_read_b128 v[132:135], v13 offset:768
    s_waitcnt lgkmcnt(9)
    v_mfma_f32_32x32x16_bf16 v[64:79], v[104:107], v[108:111], v[64:79]
    ds_read_b64_tr_b16 v[96:97], v24 offset:26624
    ds_read_b64_tr_b16 v[98:99], v24 offset:27648
    ds_read_b128 v[100:103], v13 offset:800
    s_waitcnt lgkmcnt(9)
    v_mfma_f32_32x32x16_bf16 v[64:79], v[112:115], v[116:119], v[64:79]
    ds_read_b64_tr_b16 v[104:105], v24 offset:32768
    ds_read_b64_tr_b16 v[106:107], v24 offset:33792
    ds_read_b128 v[108:111], v13 offset:832
    s_waitcnt lgkmcnt(9)
    v_mfma_f32_32x32x16_bf16 v[64:79], v[120:123], v[124:127], v[64:79]
    ds_read_b64_tr_b16 v[112:113], v24 offset:34816
    ds_read_b64_tr_b16 v[114:115], v24 offset:35840
    ds_read_b128 v[116:119], v13 offset:864
    s_waitcnt lgkmcnt(9)
    v_mfma_f32_32x32x16_bf16 v[64:79], v[128:131], v[132:135], v[64:79]
    ds_read_b64_tr_b16 v[120:121], v24 offset:40960
    ds_read_b64_tr_b16 v[122:123], v24 offset:41984
    ds_read_b128 v[124:127], v13 offset:896
    s_waitcnt lgkmcnt(9)
    v_mfma_f32_32x32x16_bf16 v[64:79], v[96:99], v[100:103], v[64:79]
    ds_read_b64_tr_b16 v[128:129], v24 offset:43008
    ds_read_b64_tr_b16 v[130:131], v24 offset:44032
    ds_read_b128 v[132:135], v13 offset:928
    s_waitcnt lgkmcnt(9)
    v_mfma_f32_32x32x16_bf16 v[64:79], v[104:107], v[108:111], v[64:79]
    ds_read_b64_tr_b16 v[96:97], v24 offset:49152
    ds_read_b64_tr_b16 v[98:99], v24 offset:50176
    ds_read_b128 v[100:103], v13 offset:960
    s_waitcnt lgkmcnt(9)
    v_mfma_f32_32x32x16_bf16 v[64:79], v[112:115], v[116:119], v[64:79]
    ds_read_b64_tr_b16 v[104:105], v24 offset:51200
    ds_read_b64_tr_b16 v[106:107], v24 offset:52224
    ds_read_b128 v[108:111], v13 offset:992
    s_waitcnt lgkmcnt(9)
    v_mfma_f32_32x32x16_bf16 v[64:79], v[120:123], v[124:127], v[64:79]
    s_waitcnt lgkmcnt(6)
    v_mfma_f32_32x32x16_bf16 v[64:79], v[128:131], v[132:135], v[64:79]
    s_waitcnt lgkmcnt(3)
    v_mfma_f32_32x32x16_bf16 v[64:79], v[96:99], v[100:103], v[64:79]
    s_waitcnt lgkmcnt(0)
    v_mfma_f32_32x32x16_bf16 v[64:79], v[104:107], v[108:111], v[64:79]
    s_mov_b32 s77, s75
    s_lshl_b32 s76, s77, 10
    s_lshl_b32 s78, s3, 8
    s_add_u32 s76, s76, s78
    s_add_u32 s76, s76, 393216
    v_and_b32 v13, 1, v1
    v_lshlrev_b32 v13, 7, v13
    v_lshrrev_b32 v15, 5, v1
    v_lshl_add_u32 v13, v15, 4, v13
    s_cmp_ge_u32 s77, 28
    s_cbranch_scc1 L_s4
    v_mov_b32 v15, 0xffffff00
    s_bfe_u32 s78, s68, 0x80000
    v_and_or_b32 v64, v64, v15, s78
    v_and_or_b32 v68, v68, v15, s78
    v_and_or_b32 v72, v72, v15, s78
    v_and_or_b32 v76, v76, v15, s78
    s_bfe_u32 s78, s68, 0x80008
    v_and_or_b32 v65, v65, v15, s78
    v_and_or_b32 v69, v69, v15, s78
    v_and_or_b32 v73, v73, v15, s78
    v_and_or_b32 v77, v77, v15, s78
    s_bfe_u32 s78, s68, 0x80010
    v_and_or_b32 v66, v66, v15, s78
    v_and_or_b32 v70, v70, v15, s78
    v_and_or_b32 v74, v74, v15, s78
    v_and_or_b32 v78, v78, v15, s78
    s_bfe_u32 s78, s68, 0x80018
    v_and_or_b32 v67, v67, v15, s78
    v_and_or_b32 v71, v71, v15, s78
    v_and_or_b32 v75, v75, v15, s78
    v_and_or_b32 v79, v79, v15, s78
    s_mov_b32 exec_lo, 3
    s_mov_b32 exec_hi, 3
    buffer_store_dwordx4 v[64:67], v13, s[60:63], s76 offen offset:0 sc1
    buffer_store_dwordx4 v[68:71], v13, s[60:63], s76 offen offset:32 sc1
    buffer_store_dwordx4 v[72:75], v13, s[60:63], s76 offen offset:64 sc1
    buffer_store_dwordx4 v[76:79], v13, s[60:63], s76 offen offset:96 sc1
    s_mov_b64 exec, -1
L_s4:
    s_barrier
    s_barrier
    s_barrier
    s_barrier
    s_barrier
    s_barrier
    s_barrier
    s_barrier
    s_branch L_p4r
L_h:
    s_waitcnt vmcnt(16) lgkmcnt(0)
    s_barrier
    v_readfirstlane_b32 s76, v225
    s_nop 0
    s_mul_i32 s77, s76, 0x9E3779B1
    s_lshr_b32 s78, s77, 15
    s_xor_b32 s77, s77, s78
    s_or_b32 s77, s77, 0x01010101
    s_xor_b32 s68, s76, s77
    s_setprio 3
    s_barrier
    s_lshr_b32 s77, s2, 3
    s_mul_i32 s78, s77, 37
    s_lshr_b32 s78, s78, 8
    s_mul_i32 s79, s78, 7
    s_sub_u32 s79, s77, s79
    s_lshl_b32 s81, s78, 2
    s_and_b32 s28, s81, 15
    s_and_b32 s81, s2, 6
    s_lshl_b32 s81, s81, 1
    s_add_u32 s56, s81, s78
    s_min_u32 s56, s56, 15
    s_and_b32 s78, s2, 1
    s_barrier
    s_add_u32 m0, s91, 0
    s_add_u32 s76, s90, s72
    buffer_load_dwordx4 v9, s[36:39], s76 offen lds
    s_add_u32 m0, s91, 4096
    s_add_u32 s76, s90, s72
    s_add_u32 s76, s76, 1024
    buffer_load_dwordx4 v9, s[36:39], s76 offen lds
    s_add_u32 m0, s91, 8192
    s_add_u32 s76, s90, s72
    s_add_u32 s76, s76, 2048
    buffer_load_dwordx4 v9, s[36:39], s76 offen lds
    s_add_u32 s72, s72, 98304
    s_cmp_ge_u32 s72, 1572864
    s_cselect_b32 s72, 0, s72
    s_mul_i32 s78, s78, 7
    s_add_u32 s57, s78, s79
    s_add_u32 s81, s81, s79
    s_lshl_b32 s78, s78, 1
    s_add_u32 s78, s78, s81
    s_cmp_ge_u32 s81, 14
    s_cselect_b32 s78, 31, s78
    s_lshl_b32 s59, s57, 1
    s_cmp_ge_u32 s77, 28
    s_cselect_b32 s57, 14, s57
    s_cselect_b32 s88, s78, s59
    s_cselect_b32 s28, 0, s28
    s_waitcnt vmcnt(16)
    s_barrier
    s_add_u32 m0, s91, 12288
    s_add_u32 s76, s90, s72
    buffer_load_dwordx4 v9, s[36:39], s76 offen lds
    s_add_u32 m0, s91, 16384
    s_add_u32 s76, s90, s72
    s_add_u32 s76, s76, 1024
    buffer_load_dwordx4 v9, s[36:39], s76 offen lds
    s_add_u32 m0, s91, 20480
    s_add_u32 s76, s90, s72
    s_add_u32 s76, s76, 2048
    buffer_load_dwordx4 v9, s[36:39], s76 offen lds
    s_add_u32 s72, s72, 98304
    s_cmp_ge_u32 s72, 1572864
    s_cselect_b32 s72, 0, s72
    s_lshl_b32 s58, s56, 11
    s_add_u32 s58, s58, 4096
    s_mov_b32 s75, s88
    v_and_b32 v14, 1, v6
    v_lshlrev_b32 v15, 2, v14
    v_xor_b32 v15, v15, v5
    v_lshlrev_b32 v15, 4, v15
    v_lshl_add_u32 v240, v4, 10, v15
    v_lshlrev_b32 v15, 1, v14
    v_xor_b32 v15, v15, v5
    v_mul_u32_u24 v14, 3584, v4
    v_lshl_add_u32 v241, v15, 4, v14
    s_waitcnt vmcnt(16)
    s_barrier
    s_add_u32 m0, s91, 24576
    s_add_u32 s76, s90, s72
    buffer_load_dwordx4 v9, s[36:39], s76 offen lds
    s_add_u32 m0, s91, 28672
    s_add_u32 s76, s90, s72
    s_add_u32 s76, s76, 1024
    buffer_load_dwordx4 v9, s[36:39], s76 offen lds
    s_add_u32 m0, s91, 32768
    s_add_u32 s76, s90, s72
    s_add_u32 s76, s76, 2048
    buffer_load_dwordx4 v9, s[36:39], s76 offen lds
    s_add_u32 s72, s72, 98304
    s_cmp_ge_u32 s72, 1572864
    s_cselect_b32 s72, 0, s72
    v_xor_b32 v15, 4, v15
    v_lshl_add_u32 v242, v15, 4, v14
    s_min_u32 s77, s75, 27
    s_lshl_b32 s77, s77, 7
    s_mul_i32 s69, s74, 28672
    s_add_u32 s69, s69, s77
    s_lshl_b32 s70, s74, 10
    s_add_u32 s70, s70, 8192
    s_lshl_b32 s71, s74, 13
    s_lshl_b32 s77, s7, 7
    s_add_u32 s71, s71, s77
    v_mov_b32 v243, v6
    s_waitcnt vmcnt(16)
    s_barrier
    s_add_u32 m0, s91, 36864
    s_add_u32 s76, s90, s72
    buffer_load_dwordx4 v9, s[36:39], s76 offen lds
    s_add_u32 m0, s91, 40960
    s_add_u32 s76, s90, s72
    s_add_u32 s76, s76, 1024
    buffer_load_dwordx4 v9, s[36:39], s76 offen lds
    s_add_u32 m0, s91, 45056
    s_add_u32 s76, s90, s72
    s_add_u32 s76, s76, 2048
    buffer_load_dwordx4 v9, s[36:39], s76 offen lds
    s_add_u32 s72, s72, 98304
    s_cmp_ge_u32 s72, 1572864
    s_cselect_b32 s72, 0, s72
    s_mul_i32 s85, s28, 114688
    s_and_b32 s77, s6, 3
    s_mul_i32 s77, s77, 3
    s_lshl_b32 s78, s7, 1
    s_add_u32 s77, s77, s78
    s_sub_u32 s78, s77, 14
    s_cmp_ge_u32 s77, 14
    s_cselect_b32 s77, s78, s77
    s_lshl_b32 s86, s77, 17
    s_mov_b32 s87, s86
    s_add_u32 s87, s87, 131072
    s_cmp_ge_u32 s87, 1835008
    s_cselect_b32 s87, 0, s87
    s_waitcnt vmcnt(9)
    s_barrier
    s_add_u32 m0, s91, 49152
    s_add_u32 s76, s90, s72
    buffer_load_dwordx4 v9, s[36:39], s76 offen lds
    s_add_u32 m0, s91, 53248
    s_add_u32 s76, s90, s72
    s_add_u32 s76, s76, 1024
    buffer_load_dwordx4 v9, s[36:39], s76 offen lds
    s_add_u32 m0, s91, 57344
    s_add_u32 s76, s90, s72
    s_add_u32 s76, s76, 2048
    buffer_load_dwordx4 v9, s[36:39], s76 offen lds
    s_add_u32 s72, s72, 98304
    s_cmp_ge_u32 s72, 1572864
    s_cselect_b32 s72, 0, s72
    s_add_u32 s87, s87, 131072
    s_cmp_ge_u32 s87, 1835008
    s_cselect_b32 s87, 0, s87
    s_add_u32 s87, s87, 131072
    s_cmp_ge_u32 s87, 1835008
    s_cselect_b32 s87, 0, s87
    s_add_u32 s87, s87, 131072
    s_cmp_ge_u32 s87, 1835008
    s_cselect_b32 s87, 0, s87
    s_add_u32 s87, s87, 131072
    s_cmp_ge_u32 s87, 1835008
    s_cselect_b32 s87, 0, s87
    s_waitcnt vmcnt(9)
    s_barrier
    s_add_u32 m0, s91, 61440
    s_add_u32 s76, s90, s72
    buffer_load_dwordx4 v9, s[36:39], s76 offen lds
    s_add_u32 m0, s91, 65536
    s_add_u32 s76, s90, s72
    s_add_u32 s76, s76, 1024
    buffer_load_dwordx4 v9, s[36:39], s76 offen lds
    s_add_u32 m0, s91, 69632
    s_add_u32 s76, s90, s72
    s_add_u32 s76, s76, 2048
    buffer_load_dwordx4 v9, s[36:39], s76 offen lds
    s_add_u32 s72, s72, 98304
    s_cmp_ge_u32 s72, 1572864
    s_cselect_b32 s72, 0, s72
    s_add_u32 s87, s87, 131072
    s_cmp_ge_u32 s87, 1835008
    s_cselect_b32 s87, 0, s87
    s_add_u32 s87, s87, 131072
    s_cmp_ge_u32 s87, 1835008
    s_cselect_b32 s87, 0, s87
    s_add_u32 s87, s87, 131072
    s_cmp_ge_u32 s87, 1835008
    s_cselect_b32 s87, 0, s87
    s_add_u32 s87, s87, 131072
    s_cmp_ge_u32 s87, 1835008
    s_cselect_b32 s87, 0, s87
    s_waitcnt vmcnt(9)
    s_barrier
    s_add_u32 m0, s91, 0
    s_add_u32 s76, s90, s72
    buffer_load_dwordx4 v9, s[36:39], s76 offen lds
    s_add_u32 m0, s91, 4096
    s_add_u32 s76, s90, s72
    s_add_u32 s76, s76, 1024
    buffer_load_dwordx4 v9, s[36:39], s76 offen lds
    s_add_u32 m0, s91, 8192
    s_add_u32 s76, s90, s72
    s_add_u32 s76, s76, 2048
    buffer_load_dwordx4 v9, s[36:39], s76 offen lds
    s_add_u32 s72, s72, 98304
    s_cmp_ge_u32 s72, 1572864
    s_cselect_b32 s72, 0, s72
    s_add_u32 s87, s87, 131072
    s_cmp_ge_u32 s87, 1835008
    s_cselect_b32 s87, 0, s87
    s_add_u32 s87, s87, 131072
    s_cmp_ge_u32 s87, 1835008
    s_cselect_b32 s87, 0, s87
    s_add_u32 s87, s87, 131072
    s_cmp_ge_u32 s87, 1835008
    s_cselect_b32 s87, 0, s87
    s_lshl_b32 s84, s7, 15
    v_and_b32 v13, 127, v0
    v_lshrrev_b32 v230, 5, v13
    s_waitcnt vmcnt(9)
    s_barrier
    s_add_u32 m0, s91, 12288
    s_add_u32 s76, s90, s72
    buffer_load_dwordx4 v9, s[36:39], s76 offen lds
    s_add_u32 m0, s91, 16384
    s_add_u32 s76, s90, s72
    s_add_u32 s76, s76, 1024
    buffer_load_dwordx4 v9, s[36:39], s76 offen lds
    s_add_u32 m0, s91, 20480
    s_add_u32 s76, s90, s72
    s_add_u32 s76, s76, 2048
    buffer_load_dwordx4 v9, s[36:39], s76 offen lds
    s_add_u32 s72, s72, 98304
    s_cmp_ge_u32 s72, 1572864
    s_cselect_b32 s72, 0, s72
    v_lshlrev_b32 v230, 6, v230
    v_bfe_u32 v14, v13, 2, 2
    v_lshl_add_u32 v230, v14, 4, v230
    v_and_b32 v14, 3, v13
    v_lshl_add_u32 v230, v14, 1, v230
    v_bfe_u32 v14, v13, 4, 1
    v_lshl_add_u32 v230, v14, 3, v230
    v_and_b32 v2, 15, v1
    v_lshrrev_b32 v228, 2, v2
    v_and_b32 v227, 1, v6
    v_lshl_add_u32 v228, v227, 2, v228
    v_bfe_u32 v227, v2, 1, 1
    s_waitcnt vmcnt(9)
    s_barrier
    s_add_u32 m0, s91, 24576
    s_add_u32 s76, s90, s72
    buffer_load_dwordx4 v9, s[36:39], s76 offen lds
    s_add_u32 m0, s91, 28672
    s_add_u32 s76, s90, s72
    s_add_u32 s76, s76, 1024
    buffer_load_dwordx4 v9, s[36:39], s76 offen lds
    s_add_u32 m0, s91, 32768
    s_add_u32 s76, s90, s72
    s_add_u32 s76, s76, 2048
    buffer_load_dwordx4 v9, s[36:39], s76 offen lds
    s_add_u32 s72, s72, 98304
    s_cmp_ge_u32 s72, 1572864
    s_cselect_b32 s72, 0, s72
    s_lshl_b32 s81, s74, 1
    v_or_b32 v227, s81, v227
    v_and_b32 v14, 6, v228
    v_xor_b32 v227, v227, v14
    v_lshlrev_b32 v227, 4, v227
    v_lshl_add_u32 v227, v228, 7, v227
    v_and_b32 v14, 1, v2
    v_lshl_add_u32 v227, v14, 3, v227
    v_lshrrev_b32 v14, 1, v6
    v_lshl_add_u32 v227, v14, 10, v227
    v_lshlrev_b32 v228, 4, v6
    v_add_u32 v227, 139264, v227
    s_waitcnt vmcnt(9)
    s_barrier
    s_add_u32 m0, s91, 36864
    s_add_u32 s76, s90, s72
    buffer_load_dwordx4 v9, s[36:39], s76 offen lds
    s_add_u32 m0, s91, 40960
    s_add_u32 s76, s90, s72
    s_add_u32 s76, s76, 1024
    buffer_load_dwordx4 v9, s[36:39], s76 offen lds
    s_add_u32 m0, s91, 45056
    s_add_u32 s76, s90, s72
    s_add_u32 s76, s76, 2048
    buffer_load_dwordx4 v9, s[36:39], s76 offen lds
    s_add_u32 s72, s72, 98304
    s_cmp_ge_u32 s72, 1572864
    s_cselect_b32 s72, 0, s72
    s_sub_u32 s76, s2, 64
    s_cmp_ge_u32 s76, 128
    s_cbranch_scc1 L_dm10
    global_load_ushort v224, v224, s[22:23]
L_dm10:
    s_waitcnt vmcnt(9)
    s_barrier
    s_waitcnt vmcnt(6)
    s_barrier
    s_sub_u32 s76, s2, 64
    s_cmp_ge_u32 s76, 128
    s_cbranch_scc1 L_dm12
    s_lshl_b32 s78, s74, 12
    s_add_u32 m0, s78, 139264
    s_add_u32 s76, s82, 0
    buffer_load_dwordx4 v3, s[32:35], s76 offen lds
    s_add_u32 m0, s78, 140288
    s_add_u32 s76, s82, 49152
    buffer_load_dwordx4 v3, s[32:35], s76 offen lds
    s_add_u32 m0, s78, 141312
    s_add_u32 s76, s82, 98304
    buffer_load_dwordx4 v3, s[32:35], s76 offen lds
    s_add_u32 m0, s78, 142336
    s_add_u32 s76, s82, 147456
    buffer_load_dwordx4 v3, s[32:35], s76 offen lds
L_dm12:
    s_waitcnt vmcnt(3)
    s_barrier
    s_waitcnt vmcnt(0)
    s_barrier
    s_barrier
    s_barrier
    s_setprio 0
    s_sub_u32 s76, s2, 64
    s_cmp_ge_u32 s76, 128
    s_cbranch_scc1 L_dm14
    s_waitcnt vmcnt(4)
    v_lshlrev_b32 v224, 16, v224
    v_mul_f32 v14, 0xbfb8aa3b, v224
    v_exp_f32 v14, v14
    s_nop 0
    v_add_f32 v14, 1.0, v14
    v_rcp_f32 v14, v14
    s_nop 0
    v_mul_f32 v224, v224, v14
    v_cvt_pk_bf16_f32 v224, v224, v224
    ds_write_b16 v230, v224 offset:4096
L_dm14:
    s_add_u32 m0, s70, 0
    s_add_u32 s76, s71, s84
    buffer_load_dwordx4 v240, s[40:43], s76 offen lds
    s_add_u32 s84, s84, 32768
    s_and_b32 s84, s84, 0x3ffff
    s_add_u32 m0, s70, 4096
    s_add_u32 s76, s71, s84
    buffer_load_dwordx4 v240, s[40:43], s76 offen lds
    s_add_u32 s84, s84, 32768
    s_and_b32 s84, s84, 0x3ffff
    s_add_u32 m0, s70, 8192
    s_add_u32 s76, s71, s84
    buffer_load_dwordx4 v240, s[40:43], s76 offen lds
    s_add_u32 s84, s84, 32768
    s_and_b32 s84, s84, 0x3ffff
    s_add_u32 m0, s70, 12288
    s_add_u32 s76, s71, s84
    buffer_load_dwordx4 v240, s[40:43], s76 offen lds
    s_add_u32 s84, s84, 32768
    s_and_b32 s84, s84, 0x3ffff
    s_add_u32 m0, s70, 16384
    s_add_u32 s76, s71, s84
    buffer_load_dwordx4 v240, s[40:43], s76 offen lds
    s_add_u32 s84, s84, 32768
    s_and_b32 s84, s84, 0x3ffff
    s_add_u32 m0, s70, 20480
    s_add_u32 s76, s71, s84
    buffer_load_dwordx4 v240, s[40:43], s76 offen lds
    s_add_u32 s84, s84, 32768
    s_and_b32 s84, s84, 0x3ffff
    s_add_u32 m0, s70, 24576
    s_add_u32 s76, s71, s84
    buffer_load_dwordx4 v240, s[40:43], s76 offen lds
    s_add_u32 s84, s84, 32768
    s_and_b32 s84, s84, 0x3ffff
    s_add_u32 m0, s70, 28672
    s_add_u32 s76, s71, s84
    buffer_load_dwordx4 v240, s[40:43], s76 offen lds
    s_add_u32 s84, s84, 32768
    s_and_b32 s84, s84, 0x3ffff
    s_add_u32 m0, s70, 32768
    s_add_u32 s76, s71, s84
    s_add_u32 s76, s76, 262144
    buffer_load_dwordx4 v240, s[40:43], s76 offen lds
    s_add_u32 s84, s84, 32768
    s_and_b32 s84, s84, 0x3ffff
    s_add_u32 m0, s70, 36864
    s_add_u32 s76, s71, s84
    s_add_u32 s76, s76, 262144
    buffer_load_dwordx4 v240, s[40:43], s76 offen lds
    s_add_u32 s84, s84, 32768
    s_and_b32 s84, s84, 0x3ffff
    s_add_u32 m0, s70, 40960
    s_add_u32 s76, s71, s84
    s_add_u32 s76, s76, 262144
    buffer_load_dwordx4 v240, s[40:43], s76 offen lds
    s_add_u32 s84, s84, 32768
    s_and_b32 s84, s84, 0x3ffff
    s_add_u32 m0, s70, 45056
    s_add_u32 s76, s71, s84
    s_add_u32 s76, s76, 262144
    buffer_load_dwordx4 v240, s[40:43], s76 offen lds
    s_add_u32 s84, s84, 32768
    s_and_b32 s84, s84, 0x3ffff
    s_add_u32 m0, s70, 49152
    s_add_u32 s76, s71, s84
    s_add_u32 s76, s76, 262144
    buffer_load_dwordx4 v240, s[40:43], s76 offen lds
    s_add_u32 s84, s84, 32768
    s_and_b32 s84, s84, 0x3ffff
    s_add_u32 m0, s70, 53248
    s_add_u32 s76, s71, s84
    s_add_u32 s76, s76, 262144
    buffer_load_dwordx4 v240, s[40:43], s76 offen lds
    s_add_u32 s84, s84, 32768
    s_and_b32 s84, s84, 0x3ffff
    s_add_u32 m0, s70, 57344
    s_add_u32 s76, s71, s84
    s_add_u32 s76, s76, 262144
    buffer_load_dwordx4 v240, s[40:43], s76 offen lds
    s_add_u32 s84, s84, 32768
    s_and_b32 s84, s84, 0x3ffff
    s_add_u32 m0, s70, 61440
    s_add_u32 s76, s71, s84
    s_add_u32 s76, s76, 262144
    buffer_load_dwordx4 v240, s[40:43], s76 offen lds
    s_add_u32 s84, s84, 32768
    s_and_b32 s84, s84, 0x3ffff
    s_add_u32 m0, s70, 65536
    s_add_u32 s76, s69, s85
    buffer_load_dwordx4 v241, s[44:47], s76 offen lds
    s_add_u32 m0, s70, 69632
    s_add_u32 s85, s85, 114688
    s_cmp_ge_u32 s85, 1835008
    s_cselect_b32 s85, 0, s85
    buffer_load_dwordx4 v242, s[48:51], s76 offen lds
    s_waitcnt vmcnt(2)
    s_waitcnt lgkmcnt(0)
    s_barrier
    s_sub_u32 s76, s2, 64
    s_cmp_ge_u32 s76, 128
    s_cbranch_scc1 L_dmx
    ds_read_b64_tr_b16 v[144:145], v227 offset:0
    ds_read_b64_tr_b16 v[146:147], v227 offset:2048
    ds_read_b128 v[160:163], v228 offset:4096
    ds_read_b64_tr_b16 v[148:149], v227 offset:4096
    ds_read_b64_tr_b16 v[150:151], v227 offset:6144
    ds_read_b128 v[164:167], v228 offset:4160
    ds_read_b64_tr_b16 v[152:153], v227 offset:8192
    ds_read_b64_tr_b16 v[154:155], v227 offset:10240
    ds_read_b128 v[168:171], v228 offset:4224
    ds_read_b64_tr_b16 v[156:157], v227 offset:12288
    ds_read_b64_tr_b16 v[158:159], v227 offset:14336
    ds_read_b128 v[172:175], v228 offset:4288
    v_mov_b32 v14, 0xffffff00
    s_waitcnt lgkmcnt(9)
    v_mfma_f32_16x16x32_bf16 v[232:235], v[144:147], v[160:163], 0
    s_waitcnt lgkmcnt(6)
    v_mfma_f32_16x16x32_bf16 v[232:235], v[148:151], v[164:167], v[232:235]
    s_waitcnt lgkmcnt(3)
    v_mfma_f32_16x16x32_bf16 v[232:235], v[152:155], v[168:171], v[232:235]
    s_waitcnt lgkmcnt(0)
    v_mfma_f32_16x16x32_bf16 v[232:235], v[156:159], v[172:175], v[232:235]
    s_nop 6
    s_bfe_u32 s76, s68, 0x80000
    v_and_or_b32 v232, v232, v14, s76
    s_bfe_u32 s76, s68, 0x80008
    v_and_or_b32 v233, v233, v14, s76
    s_bfe_u32 s76, s68, 0x80010
    v_and_or_b32 v234, v234, v14, s76
    s_bfe_u32 s76, s68, 0x80018
    v_and_or_b32 v235, v235, v14, s76
    s_mov_b32 exec_lo, 0x00010001
    s_mov_b32 exec_hi, 0x00010001
    buffer_store_dwordx4 v[232:235], v228, s[60:63], s83 offen sc1
    s_mov_b64 exec, -1
L_dmx:
    s_add_u32 m0, s70, 73728
    s_add_u32 s76, s69, s85
    buffer_load_dwordx4 v241, s[44:47], s76 offen lds
    s_add_u32 m0, s70, 77824
    s_add_u32 s85, s85, 114688
    s_cmp_ge_u32 s85, 1835008
    s_cselect_b32 s85, 0, s85
    buffer_load_dwordx4 v242, s[48:51], s76 offen lds
    s_add_u32 m0, s70, 81920
    s_add_u32 s76, s69, s85
    buffer_load_dwordx4 v241, s[44:47], s76 offen lds
    s_add_u32 m0, s70, 86016
    s_add_u32 s85, s85, 114688
    s_cmp_ge_u32 s85, 1835008
    s_cselect_b32 s85, 0, s85
    buffer_load_dwordx4 v242, s[48:51], s76 offen lds
    s_add_u32 m0, s70, 90112
    s_add_u32 s76, s69, s85
    buffer_load_dwordx4 v241, s[44:47], s76 offen lds
    s_add_u32 m0, s70, 94208
    s_add_u32 s85, s85, 114688
    s_cmp_ge_u32 s85, 1835008
    s_cselect_b32 s85, 0, s85
    buffer_load_dwordx4 v242, s[48:51], s76 offen lds
    s_add_u32 m0, s70, 98304
    s_add_u32 s76, s69, s85
    buffer_load_dwordx4 v241, s[44:47], s76 offen lds
    s_add_u32 m0, s70, 102400
    s_add_u32 s85, s85, 114688
    s_cmp_ge_u32 s85, 1835008
    s_cselect_b32 s85, 0, s85
    buffer_load_dwordx4 v242, s[48:51], s76 offen lds
    s_add_u32 m0, s70, 106496
    s_add_u32 s76, s69, s85
    buffer_load_dwordx4 v241, s[44:47], s76 offen lds
    s_add_u32 m0, s70, 110592
    s_add_u32 s85, s85, 114688
    s_cmp_ge_u32 s85, 1835008
    s_cselect_b32 s85, 0, s85
    buffer_load_dwordx4 v242, s[48:51], s76 offen lds
    s_add_u32 m0, s70, 114688
    s_add_u32 s76, s69, s85
    buffer_load_dwordx4 v241, s[44:47], s76 offen lds
    s_add_u32 m0, s70, 118784
    s_add_u32 s85, s85, 114688
    s_cmp_ge_u32 s85, 1835008
    s_cselect_b32 s85, 0, s85
    buffer_load_dwordx4 v242, s[48:51], s76 offen lds
    s_add_u32 m0, s70, 122880
    s_add_u32 s76, s69, s85
    buffer_load_dwordx4 v241, s[44:47], s76 offen lds
    s_add_u32 m0, s70, 126976
    s_add_u32 s85, s85, 114688
    s_cmp_ge_u32 s85, 1835008
    s_cselect_b32 s85, 0, s85
    buffer_load_dwordx4 v242, s[48:51], s76 offen lds
    s_barrier
    s_cmp_eq_u32 s3, 4
    s_cbranch_scc0 L_nk2
    v_lshlrev_b32 v18, 10, v243
    v_lshlrev_b32 v15, 9, v243
    v_and_b32 v15, 0x400, v15
    v_lshrrev_b32 v15, 1, v15
    v_sub_u32 v18, v18, v15
    s_lshl_b32 s76, s7, 6
    s_add_u32 s76, s76, 1024
    v_and_b32 v15, 15, v1
    v_lshl_add_u32 v18, v15, 2, v18
    v_add_lshl_u32 v18, v18, s76, 2
    v_lshlrev_b32 v15, 4, v15
    v_lshl_add_u32 v19, v243, 8, v15
    v_cmp_eq_u32 vcc, 1, v243
    v_mov_b32 v16, 0
    s_mov_b32 exec_hi, 0xffff
    v_cndmask_b32_e64 v16, v16, 1.0, vcc
    v_mov_b32 v220, 0x0c0c0400
    v_mov_b32 v221, 0x04000c0c
    s_mov_b32 s88, 0
L_pm2:
    s_mov_b32 s76, 65536
    buffer_load_dwordx4 v[200:203], v18, s[60:63], s76 offen sc1
    s_mov_b32 s76, 77824
    buffer_load_dwordx4 v[204:207], v18, s[60:63], s76 offen sc1
    s_mov_b32 s76, 90112
    buffer_load_dwordx4 v[208:211], v18, s[60:63], s76 offen sc1
    s_mov_b32 s76, 102400
    buffer_load_dwordx4 v[212:215], v18, s[60:63], s76 offen sc1
L_pm2_c:
    s_add_u32 s88, s88, 1
    s_cmp_gt_u32 s88, 0x40000
    s_cbranch_scc1 L_pm2_x
    s_waitcnt vmcnt(3)
    v_perm_b32 v217, v201, v200, v220
    v_perm_b32 v218, v203, v202, v221
    v_or_b32 v216, v217, v218
    v_xor_b32 v216, s68, v216
    s_waitcnt vmcnt(2)
    v_perm_b32 v217, v205, v204, v220
    v_perm_b32 v218, v207, v206, v221
    v_or_b32 v217, v217, v218
    v_xor_b32 v217, s68, v217
    v_or_b32 v216, v216, v217
    s_waitcnt vmcnt(1)
    v_perm_b32 v217, v209, v208, v220
    v_perm_b32 v218, v211, v210, v221
    v_or_b32 v217, v217, v218
    v_xor_b32 v217, s68, v217
    v_or_b32 v216, v216, v217
    s_waitcnt vmcnt(0)
    v_perm_b32 v217, v213, v212, v220
    v_perm_b32 v218, v215, v214, v221
    v_or_b32 v217, v217, v218
    v_xor_b32 v217, s68, v217
    v_or_b32 v216, v216, v217
    v_cmp_ne_u32 vcc, 0, v216
    s_cbranch_vccnz L_pm2
L_pm2_x:
    s_waitcnt vmcnt(0)
    v_and_b32 v200, 0xffffff00, v200
    v_and_b32 v201, 0xffffff00, v201
    v_and_b32 v202, 0xffffff00, v202
    v_and_b32 v203, 0xffffff00, v203
    v_and_b32 v204, 0xffffff00, v204
    v_and_b32 v205, 0xffffff00, v205
    v_and_b32 v206, 0xffffff00, v206
    v_and_b32 v207, 0xffffff00, v207
    v_and_b32 v208, 0xffffff00, v208
    v_and_b32 v209, 0xffffff00, v209
    v_and_b32 v210, 0xffffff00, v210
    v_and_b32 v211, 0xffffff00, v211
    v_and_b32 v212, 0xffffff00, v212
    v_and_b32 v213, 0xffffff00, v213
    v_and_b32 v214, 0xffffff00, v214
    v_and_b32 v215, 0xffffff00, v215
    v_pk_add_f32 v[200:201], v[200:201], v[204:205]
    v_pk_add_f32 v[202:203], v[202:203], v[206:207]
    v_pk_add_f32 v[208:209], v[208:209], v[212:213]
    v_pk_add_f32 v[210:211], v[210:211], v[214:215]
    v_pk_add_f32 v[200:201], v[200:201], v[208:209]
    v_pk_add_f32 v[202:203], v[202:203], v[210:211]
    v_cvt_pk_bf16_f32 v216, v200, v201
    v_cvt_pk_bf16_f32 v217, v202, v203
    v_lshlrev_b32 v200, 16, v216
    v_and_b32 v201, 0xffff0000, v216
    v_lshlrev_b32 v202, 16, v217
    v_and_b32 v203, 0xffff0000, v217
    v_add_f32 v200, v16, v200
    v_add_f32 v201, v16, v201
    v_add_f32 v202, v16, v202
    v_add_f32 v203, v16, v203
    v_cvt_pk_bf16_f32 v216, v200, v201
    v_cvt_pk_bf16_f32 v217, v202, v203
    v_lshlrev_b32 v200, 16, v216
    v_and_b32 v201, 0xffff0000, v216
    v_lshlrev_b32 v202, 16, v217
    v_and_b32 v203, 0xffff0000, v217
    ds_write_b128 v19, v[200:203] offset:4352
    s_mov_b64 exec, -1
L_nk2:
    s_cmp_ge_u32 s57, 14
    s_cbranch_scc0 L_nsp
    v_subrev_u32 v16, 256, v0
    v_lshlrev_b32 v15, 4, v16
    v_add_u32 v15, 6144, v15
    v_mov_b32 v220, 0x0c0c0400
    v_mov_b32 v221, 0x04000c0c
    s_mov_b32 s88, 0
L_pm3:
    s_mov_b32 s76, 65536
    buffer_load_dwordx4 v[200:203], v15, s[60:63], s76 offen sc1
    s_mov_b32 s76, 77824
    buffer_load_dwordx4 v[204:207], v15, s[60:63], s76 offen sc1
    s_mov_b32 s76, 90112
    buffer_load_dwordx4 v[208:211], v15, s[60:63], s76 offen sc1
    s_mov_b32 s76, 102400
    buffer_load_dwordx4 v[212:215], v15, s[60:63], s76 offen sc1
L_pm3_c:
    s_add_u32 s88, s88, 1
    s_cmp_gt_u32 s88, 0x40000
    s_cbranch_scc1 L_pm3_x
    s_waitcnt vmcnt(3)
    v_perm_b32 v217, v201, v200, v220
    v_perm_b32 v218, v203, v202, v221
    v_or_b32 v216, v217, v218
    v_xor_b32 v216, s68, v216
    s_waitcnt vmcnt(2)
    v_perm_b32 v217, v205, v204, v220
    v_perm_b32 v218, v207, v206, v221
    v_or_b32 v217, v217, v218
    v_xor_b32 v217, s68, v217
    v_or_b32 v216, v216, v217
    s_waitcnt vmcnt(1)
    v_perm_b32 v217, v209, v208, v220
    v_perm_b32 v218, v211, v210, v221
    v_or_b32 v217, v217, v218
    v_xor_b32 v217, s68, v217
    v_or_b32 v216, v216, v217
    s_waitcnt vmcnt(0)
    v_perm_b32 v217, v213, v212, v220
    v_perm_b32 v218, v215, v214, v221
    v_or_b32 v217, v217, v218
    v_xor_b32 v217, s68, v217
    v_or_b32 v216, v216, v217
    v_cmp_ne_u32 vcc, 0, v216
    s_cbranch_vccnz L_pm3
L_pm3_x:
    s_waitcnt vmcnt(0)
    v_and_b32 v200, 0xffffff00, v200
    v_and_b32 v201, 0xffffff00, v201
    v_and_b32 v202, 0xffffff00, v202
    v_and_b32 v203, 0xffffff00, v203
    v_and_b32 v204, 0xffffff00, v204
    v_and_b32 v205, 0xffffff00, v205
    v_and_b32 v206, 0xffffff00, v206
    v_and_b32 v207, 0xffffff00, v207
    v_and_b32 v208, 0xffffff00, v208
    v_and_b32 v209, 0xffffff00, v209
    v_and_b32 v210, 0xffffff00, v210
    v_and_b32 v211, 0xffffff00, v211
    v_and_b32 v212, 0xffffff00, v212
    v_and_b32 v213, 0xffffff00, v213
    v_and_b32 v214, 0xffffff00, v214
    v_and_b32 v215, 0xffffff00, v215
    v_pk_add_f32 v[200:201], v[200:201], v[204:205]
    v_pk_add_f32 v[202:203], v[202:203], v[206:207]
    v_pk_add_f32 v[208:209], v[208:209], v[212:213]
    v_pk_add_f32 v[210:211], v[210:211], v[214:215]
    v_pk_add_f32 v[200:201], v[200:201], v[208:209]
    v_pk_add_f32 v[202:203], v[202:203], v[210:211]
    v_cvt_pk_bf16_f32 v216, v200, v201
    v_cvt_pk_bf16_f32 v217, v202, v203
    v_lshlrev_b32 v200, 16, v216
    v_and_b32 v201, 0xffff0000, v216
    v_lshlrev_b32 v202, 16, v217
    v_and_b32 v203, 0xffff0000, v217
    s_cmp_ge_u32 s3, 6
    s_cselect_b32 s76, 1.0, 0
    s_cselect_b32 s77, 0, 1024
    v_add_f32 v200, s76, v200
    v_add_f32 v201, s76, v201
    v_add_f32 v202, s76, v202
    v_add_f32 v203, s76, v203
    v_cvt_pk_bf16_f32 v200, v200, v201
    v_cvt_pk_bf16_f32 v201, v202, v203
    v_and_b32 v16, 127, v16
    v_lshrrev_b32 v15, 2, v16
    v_lshlrev_b32 v15, 5, v15
    v_and_b32 v28, 1, v16
    v_lshl_add_u32 v15, v28, 4, v15
    v_bfe_u32 v28, v16, 1, 1
    v_lshl_add_u32 v15, v28, 3, v15
    v_add_u32 v15, s77, v15
    ds_write_b64 v15, v[200:201] offset:0
L_nsp:
    s_waitcnt lgkmcnt(0)
    s_barrier
    s_add_u32 m0, s70, 131072
    s_add_u32 s76, s69, s85
    buffer_load_dwordx4 v241, s[44:47], s76 offen lds
    s_add_u32 m0, s70, 135168
    s_add_u32 s85, s85, 114688
    s_cmp_ge_u32 s85, 1835008
    s_cselect_b32 s85, 0, s85
    buffer_load_dwordx4 v242, s[48:51], s76 offen lds
    s_add_u32 m0, s70, 0
    s_add_u32 s76, s69, s85
    buffer_load_dwordx4 v241, s[44:47], s76 offen lds
    s_add_u32 m0, s70, 4096
    s_add_u32 s85, s85, 114688
    s_cmp_ge_u32 s85, 1835008
    s_cselect_b32 s85, 0, s85
    buffer_load_dwordx4 v242, s[48:51], s76 offen lds
    s_add_u32 m0, s70, 8192
    s_add_u32 s76, s69, s85
    buffer_load_dwordx4 v241, s[44:47], s76 offen lds
    s_add_u32 m0, s70, 12288
    s_add_u32 s85, s85, 114688
    s_cmp_ge_u32 s85, 1835008
    s_cselect_b32 s85, 0, s85
    buffer_load_dwordx4 v242, s[48:51], s76 offen lds
    s_waitcnt vmcnt(18)
    s_barrier
    s_add_u32 m0, s70, 16384
    s_add_u32 s76, s69, s85
    buffer_load_dwordx4 v241, s[44:47], s76 offen lds
    s_add_u32 m0, s70, 20480
    s_add_u32 s85, s85, 114688
    s_cmp_ge_u32 s85, 1835008
    s_cselect_b32 s85, 0, s85
    buffer_load_dwordx4 v242, s[48:51], s76 offen lds
    s_add_u32 m0, s70, 24576
    s_add_u32 s76, s69, s85
    buffer_load_dwordx4 v241, s[44:47], s76 offen lds
    s_add_u32 m0, s70, 28672
    s_add_u32 s85, s85, 114688
    s_cmp_ge_u32 s85, 1835008
    s_cselect_b32 s85, 0, s85
    buffer_load_dwordx4 v242, s[48:51], s76 offen lds
    s_add_u32 m0, s70, 32768
    s_add_u32 s76, s69, s85
    buffer_load_dwordx4 v241, s[44:47], s76 offen lds
    s_add_u32 m0, s70, 36864
    s_add_u32 s85, s85, 114688
    s_cmp_ge_u32 s85, 1835008
    s_cselect_b32 s85, 0, s85
    buffer_load_dwordx4 v242, s[48:51], s76 offen lds
    s_add_u32 m0, s70, 40960
    s_add_u32 s76, s69, s85
    buffer_load_dwordx4 v241, s[44:47], s76 offen lds
    s_add_u32 m0, s70, 45056
    s_add_u32 s85, s85, 114688
    s_cmp_ge_u32 s85, 1835008
    s_cselect_b32 s85, 0, s85
    buffer_load_dwordx4 v242, s[48:51], s76 offen lds
    s_add_u32 m0, s70, 49152
    s_add_u32 s76, s69, s85
    buffer_load_dwordx4 v241, s[44:47], s76 offen lds
    s_add_u32 m0, s70, 53248
    s_add_u32 s85, s85, 114688
    s_cmp_ge_u32 s85, 1835008
    s_cselect_b32 s85, 0, s85
    buffer_load_dwordx4 v242, s[48:51], s76 offen lds
    s_add_u32 m0, s70, 57344
    s_add_u32 s76, s69, s85
    s_add_u32 s76, s76, 128
    buffer_load_dwordx4 v241, s[44:47], s76 offen lds
    s_add_u32 m0, s70, 61440
    s_add_u32 s85, s85, 114688
    s_cmp_ge_u32 s85, 1835008
    s_cselect_b32 s85, 0, s85
    buffer_load_dwordx4 v242, s[48:51], s76 offen lds
    s_add_u32 m0, s70, 139264
    s_add_u32 s76, s69, s85
    s_add_u32 s76, s76, 128
    buffer_load_dwordx4 v241, s[44:47], s76 offen lds
    s_add_u32 m0, s70, 143360
    s_add_u32 s85, s85, 114688
    s_cmp_ge_u32 s85, 1835008
    s_cselect_b32 s85, 0, s85
    buffer_load_dwordx4 v242, s[48:51], s76 offen lds
    s_add_u32 m0, s70, 147456
    s_add_u32 s76, s69, s85
    s_add_u32 s76, s76, 128
    buffer_load_dwordx4 v241, s[44:47], s76 offen lds
    s_add_u32 m0, s70, 151552
    s_add_u32 s85, s85, 114688
    s_cmp_ge_u32 s85, 1835008
    s_cselect_b32 s85, 0, s85
    buffer_load_dwordx4 v242, s[48:51], s76 offen lds
    s_waitcnt vmcnt(22)
    s_cmp_ge_u32 s57, 14
    s_cbranch_scc1 L_hsp1
    s_barrier
L_hsp1:
    s_setprio 0
    s_cmp_eq_u32 s3, 5
    s_cbranch_scc0 L_ngf
    s_cmp_eq_u32 s57, 0
    s_cbranch_scc0 L_ngf
    s_lshl_b32 s77, s56, 2
    s_add_u32 s77, s77, 38912
    v_mov_b32 v14, 0
    v_mov_b32 v15, s68
    s_mov_b64 exec, 1
    buffer_store_dword v15, v14, s[60:63], s77 offen sc1
    s_mov_b64 exec, -1
L_ngf:
    s_cmp_ge_u32 s57, 14
    s_cbranch_scc0 L_hsp2
    v_mov_b32 v241, 0x7fffff00
    v_mov_b32 v242, 0x7fffff00
    s_waitcnt vmcnt(0)
    s_barrier
L_hsp2:
    s_waitcnt vmcnt(14)
    s_barrier
    s_add_u32 m0, s70, 65536
    s_add_u32 s76, s69, s85
    s_add_u32 s76, s76, 128
    buffer_load_dwordx4 v241, s[44:47], s76 offen lds
    s_add_u32 m0, s70, 69632
    s_add_u32 s85, s85, 114688
    s_cmp_ge_u32 s85, 1835008
    s_cselect_b32 s85, 0, s85
    buffer_load_dwordx4 v242, s[48:51], s76 offen lds
    s_add_u32 m0, s70, 73728
    s_add_u32 s76, s69, s85
    s_add_u32 s76, s76, 128
    buffer_load_dwordx4 v241, s[44:47], s76 offen lds
    s_add_u32 m0, s70, 77824
    s_add_u32 s85, s85, 114688
    s_cmp_ge_u32 s85, 1835008
    s_cselect_b32 s85, 0, s85
    buffer_load_dwordx4 v242, s[48:51], s76 offen lds
    s_add_u32 m0, s70, 81920
    s_add_u32 s76, s69, s85
    s_add_u32 s76, s76, 128
    buffer_load_dwordx4 v241, s[44:47], s76 offen lds
    s_add_u32 m0, s70, 86016
    s_add_u32 s85, s85, 114688
    s_cmp_ge_u32 s85, 1835008
    s_cselect_b32 s85, 0, s85
    buffer_load_dwordx4 v242, s[48:51], s76 offen lds
    s_waitcnt vmcnt(12)
    s_barrier
    s_cmp_ge_u32 s57, 14
    s_cbranch_scc1 L_t2a
    v_and_b32 v14, 31, v1
    v_lshrrev_b32 v15, 5, v1
    v_lshlrev_b32 v15, 10, v15
    v_lshl_add_u32 v51, v14, 2, v15
    s_lshl_b32 s77, s57, 11
    s_lshl_b32 s78, s74, 8
    s_add_u32 s77, s77, s78
    s_add_u32 s23, s77, 393216
    v_and_b32 v15, 3, v1
    v_lshlrev_b32 v15, 3, v15
    v_mov_b32 v50, s68
    v_lshrrev_b32 v50, v15, v50
    buffer_load_dword v48, v51, s[60:63], s23 offen sc1
    buffer_load_dword v49, v51, s[60:63], s23 offen offset:128 sc1
L_t2a:
    s_add_u32 m0, s70, 90112
    s_add_u32 s76, s69, s85
    s_add_u32 s76, s76, 128
    buffer_load_dwordx4 v241, s[44:47], s76 offen lds
    s_add_u32 m0, s70, 94208
    s_add_u32 s85, s85, 114688
    s_cmp_ge_u32 s85, 1835008
    s_cselect_b32 s85, 0, s85
    buffer_load_dwordx4 v242, s[48:51], s76 offen lds
    s_add_u32 m0, s70, 98304
    s_add_u32 s76, s69, s85
    s_add_u32 s76, s76, 128
    buffer_load_dwordx4 v241, s[44:47], s76 offen lds
    s_add_u32 m0, s70, 102400
    s_add_u32 s85, s85, 114688
    s_cmp_ge_u32 s85, 1835008
    s_cselect_b32 s85, 0, s85
    buffer_load_dwordx4 v242, s[48:51], s76 offen lds
    s_add_u32 m0, s70, 106496
    s_add_u32 s76, s69, s85
    s_add_u32 s76, s76, 128
    buffer_load_dwordx4 v241, s[44:47], s76 offen lds
    s_add_u32 m0, s70, 110592
    s_add_u32 s85, s85, 114688
    s_cmp_ge_u32 s85, 1835008
    s_cselect_b32 s85, 0, s85
    buffer_load_dwordx4 v242, s[48:51], s76 offen lds
    s_add_u32 m0, s70, 114688
    s_add_u32 s76, s69, s85
    s_add_u32 s76, s76, 128
    buffer_load_dwordx4 v241, s[44:47], s76 offen lds
    s_add_u32 m0, s70, 118784
    s_add_u32 s85, s85, 114688
    s_cmp_ge_u32 s85, 1835008
    s_cselect_b32 s85, 0, s85
    buffer_load_dwordx4 v242, s[48:51], s76 offen lds
    s_add_u32 m0, s70, 122880
    s_add_u32 s76, s69, s85
    s_add_u32 s76, s76, 128
    buffer_load_dwordx4 v241, s[44:47], s76 offen lds
    s_add_u32 m0, s70, 126976
    s_add_u32 s85, s85, 114688
    s_cmp_ge_u32 s85, 1835008
    s_cselect_b32 s85, 0, s85
    buffer_load_dwordx4 v242, s[48:51], s76 offen lds
    s_waitcnt vmcnt(10)
    s_cmp_ge_u32 s57, 14
    s_cbranch_scc1 L_t2x
    s_mov_b32 s88, 0
    s_branch L_gc_c
L_gc:
    buffer_load_dword v48, v51, s[60:63], s23 offen sc1
    buffer_load_dword v49, v51, s[60:63], s23 offen offset:128 sc1
    s_waitcnt vmcnt(0)
L_gc_c:
    s_add_u32 s88, s88, 1
    s_cmp_gt_u32 s88, 0x40000
    s_cbranch_scc1 L_gc_x
    v_xor_b32 v34, v48, v50
    v_xor_b32 v35, v49, v50
    v_or_b32 v34, v34, v35
    v_and_b32 v34, 0xff, v34
    v_cmp_ne_u32 vcc, 0, v34
    s_cbranch_vccz L_gc_x
    s_sleep 4
    s_branch L_gc
L_gc_x:
    v_and_b32 v14, 31, v1
    v_lshrrev_b32 v15, 5, v1
    v_lshlrev_b32 v15, 12, v15
    v_lshl_add_u32 v14, v14, 4, v15
    s_lshl_b32 s77, s74, 9
    v_add_u32 v14, s77, v14
    v_and_b32 v48, 0xffffff00, v48
    v_and_b32 v49, 0xffffff00, v49
    v_cvt_pk_bf16_f32 v37, v48, v49
    v_lshlrev_b32 v34, 16, v37
    v_and_b32 v35, 0xffff0000, v37
    v_sub_f32 v34, v48, v34
    v_sub_f32 v35, v49, v35
    v_cvt_pk_bf16_f32 v36, v48, v34
    v_cvt_pk_bf16_f32 v38, v35, v49
    v_mov_b32 v39, 0
    ds_write_b128 v14, v[36:39] offset:2048
L_t2x:
    s_setprio 0
    s_waitcnt lgkmcnt(0)
    s_barrier
    s_add_u32 m0, s70, 131072
    s_add_u32 s76, s69, s85
    s_add_u32 s76, s76, 128
    buffer_load_dwordx4 v241, s[44:47], s76 offen lds
    s_add_u32 m0, s70, 135168
    s_add_u32 s85, s85, 114688
    s_cmp_ge_u32 s85, 1835008
    s_cselect_b32 s85, 0, s85
    buffer_load_dwordx4 v242, s[48:51], s76 offen lds
    s_waitcnt vmcnt(8)
    s_barrier
    s_add_u32 m0, s70, 0
    s_add_u32 s76, s69, s85
    s_add_u32 s76, s76, 128
    buffer_load_dwordx4 v241, s[44:47], s76 offen lds
    s_add_u32 m0, s70, 4096
    s_add_u32 s85, s85, 114688
    s_cmp_ge_u32 s85, 1835008
    s_cselect_b32 s85, 0, s85
    buffer_load_dwordx4 v242, s[48:51], s76 offen lds
    s_add_u32 m0, s70, 8192
    s_add_u32 s76, s69, s85
    s_add_u32 s76, s76, 128
    buffer_load_dwordx4 v241, s[44:47], s76 offen lds
    s_add_u32 m0, s70, 12288
    s_add_u32 s85, s85, 114688
    s_cmp_ge_u32 s85, 1835008
    s_cselect_b32 s85, 0, s85
    buffer_load_dwordx4 v242, s[48:51], s76 offen lds
    s_add_u32 m0, s70, 16384
    s_add_u32 s76, s69, s85
    s_add_u32 s76, s76, 128
    buffer_load_dwordx4 v241, s[44:47], s76 offen lds
    s_add_u32 m0, s70, 20480
    s_add_u32 s85, s85, 114688
    s_cmp_ge_u32 s85, 1835008
    s_cselect_b32 s85, 0, s85
    buffer_load_dwordx4 v242, s[48:51], s76 offen lds
    s_add_u32 m0, s70, 24576
    s_add_u32 s76, s69, s85
    s_add_u32 s76, s76, 128
    buffer_load_dwordx4 v241, s[44:47], s76 offen lds
    s_add_u32 m0, s70, 28672
    s_add_u32 s85, s85, 114688
    s_cmp_ge_u32 s85, 1835008
    s_cselect_b32 s85, 0, s85
    buffer_load_dwordx4 v242, s[48:51], s76 offen lds
    s_add_u32 m0, s70, 32768
    s_add_u32 s76, s71, s86
    buffer_load_dwordx4 v240, s[52:55], s76 offen lds
    s_add_u32 m0, s70, 36864
    s_add_u32 s76, s76, 32768
    buffer_load_dwordx4 v240, s[52:55], s76 offen lds
    s_add_u32 s86, s86, 131072
    s_cmp_ge_u32 s86, 1835008
    s_cselect_b32 s86, 0, s86
    s_add_u32 m0, s70, 40960
    s_add_u32 s76, s71, s86
    buffer_load_dwordx4 v240, s[52:55], s76 offen lds
    s_add_u32 m0, s70, 45056
    s_add_u32 s76, s76, 32768
    buffer_load_dwordx4 v240, s[52:55], s76 offen lds
    s_add_u32 s86, s86, 131072
    s_cmp_ge_u32 s86, 1835008
    s_cselect_b32 s86, 0, s86
    s_waitcnt vmcnt(12)
    s_barrier
    s_cmp_eq_u32 s3, 5
    s_cbranch_scc0 L_nfa
    s_cmp_lt_u32 s57, 14
    s_cbranch_scc0 L_nfa
    s_and_b32 s77, s2, 1
    s_mul_i32 s77, s77, 100
    s_lshl_b32 s78, s57, 2
    s_add_u32 s77, s77, s78
    s_add_u32 s77, s77, s58
    s_add_u32 s77, s77, 768
    v_lshlrev_b32 v14, 8, v1
    v_mov_b32 v15, s68
    s_mov_b64 exec, 3
    buffer_store_dword v15, v14, s[60:63], s77 offen sc1
    s_mov_b64 exec, -1
L_nfa:
    s_add_u32 m0, s70, 49152
    s_add_u32 s76, s71, s86
    buffer_load_dwordx4 v240, s[52:55], s76 offen lds
    s_add_u32 m0, s70, 53248
    s_add_u32 s76, s76, 32768
    buffer_load_dwordx4 v240, s[52:55], s76 offen lds
    s_add_u32 s86, s86, 131072
    s_cmp_ge_u32 s86, 1835008
    s_cselect_b32 s86, 0, s86
    s_add_u32 m0, s70, 57344
    s_add_u32 s76, s71, s86
    buffer_load_dwordx4 v240, s[52:55], s76 offen lds
    s_add_u32 m0, s70, 61440
    s_add_u32 s76, s76, 32768
    buffer_load_dwordx4 v240, s[52:55], s76 offen lds
    s_add_u32 s86, s86, 131072
    s_cmp_ge_u32 s86, 1835008
    s_cselect_b32 s86, 0, s86
    s_add_u32 m0, s70, 139264
    s_add_u32 s76, s71, s86
    buffer_load_dwordx4 v240, s[52:55], s76 offen lds
    s_add_u32 m0, s70, 143360
    s_add_u32 s76, s76, 32768
    buffer_load_dwordx4 v240, s[52:55], s76 offen lds
    s_add_u32 s86, s86, 131072
    s_cmp_ge_u32 s86, 1835008
    s_cselect_b32 s86, 0, s86
    s_add_u32 m0, s70, 147456
    s_add_u32 s76, s71, s86
    buffer_load_dwordx4 v240, s[52:55], s76 offen lds
    s_add_u32 m0, s70, 151552
    s_add_u32 s76, s76, 32768
    buffer_load_dwordx4 v240, s[52:55], s76 offen lds
    s_add_u32 s86, s86, 131072
    s_cmp_ge_u32 s86, 1835008
    s_cselect_b32 s86, 0, s86
    s_add_u32 m0, s70, 65536
    s_add_u32 s76, s71, s86
    buffer_load_dwordx4 v240, s[52:55], s76 offen lds
    s_add_u32 m0, s70, 69632
    s_add_u32 s76, s76, 32768
    buffer_load_dwordx4 v240, s[52:55], s76 offen lds
    s_add_u32 s86, s86, 131072
    s_cmp_ge_u32 s86, 1835008
    s_cselect_b32 s86, 0, s86
    s_add_u32 s76, s71, s87
    buffer_load_dwordx4 v[64:67], v240, s[52:55], s76 offen
    s_add_u32 s76, s76, 32768
    buffer_load_dwordx4 v[68:71], v240, s[52:55], s76 offen
    s_add_u32 s87, s87, 131072
    s_cmp_ge_u32 s87, 1835008
    s_cselect_b32 s87, 0, s87
    s_waitcnt vmcnt(16)
    s_barrier
    s_lshl_b32 s77, s73, 8
    s_add_u32 s77, s77, s89
    s_add_u32 s77, s77, 768
    v_and_b32 v14, 7, v1
    v_bfe_u32 v15, v1, 3, 1
    v_lshlrev_b32 v15, 7, v15
    v_lshl_add_u32 v14, v14, 2, v15
    s_mov_b32 s23, 0
    s_cmp_eq_u32 s3, 4
    s_cbranch_scc0 L_ga0
    buffer_load_dword v52, v14, s[60:63], s77 offen sc1
L_ga0:
    s_add_u32 m0, s70, 73728
    s_add_u32 s76, s71, s86
    buffer_load_dwordx4 v240, s[52:55], s76 offen lds
    s_add_u32 m0, s70, 77824
    s_add_u32 s76, s76, 32768
    buffer_load_dwordx4 v240, s[52:55], s76 offen lds
    s_add_u32 s86, s86, 131072
    s_cmp_ge_u32 s86, 1835008
    s_cselect_b32 s86, 0, s86
    s_add_u32 m0, s70, 81920
    s_add_u32 s76, s71, s86
    buffer_load_dwordx4 v240, s[52:55], s76 offen lds
    s_add_u32 m0, s70, 86016
    s_add_u32 s76, s76, 32768
    buffer_load_dwordx4 v240, s[52:55], s76 offen lds
    s_add_u32 s86, s86, 131072
    s_cmp_ge_u32 s86, 1835008
    s_cselect_b32 s86, 0, s86
    s_add_u32 m0, s70, 90112
    s_add_u32 s76, s71, s86
    buffer_load_dwordx4 v240, s[52:55], s76 offen lds
    s_add_u32 m0, s70, 94208
    s_add_u32 s76, s76, 32768
    buffer_load_dwordx4 v240, s[52:55], s76 offen lds
    s_add_u32 s86, s86, 131072
    s_cmp_ge_u32 s86, 1835008
    s_cselect_b32 s86, 0, s86
    s_add_u32 m0, s70, 98304
    s_add_u32 s76, s71, s86
    buffer_load_dwordx4 v240, s[52:55], s76 offen lds
    s_add_u32 m0, s70, 102400
    s_add_u32 s76, s76, 32768
    buffer_load_dwordx4 v240, s[52:55], s76 offen lds
    s_add_u32 s86, s86, 131072
    s_cmp_ge_u32 s86, 1835008
    s_cselect_b32 s86, 0, s86
    s_add_u32 s76, s71, s87
    buffer_load_dwordx4 v[72:75], v240, s[52:55], s76 offen
    s_add_u32 s76, s76, 32768
    buffer_load_dwordx4 v[76:79], v240, s[52:55], s76 offen
    s_add_u32 s87, s87, 131072
    s_cmp_ge_u32 s87, 1835008
    s_cselect_b32 s87, 0, s87
    s_add_u32 s76, s71, s87
    s_add_u32 s76, s76, 65536
    buffer_load_dwordx4 v[80:83], v240, s[52:55], s76 offen
    s_add_u32 s76, s76, 32768
    buffer_load_dwordx4 v[84:87], v240, s[52:55], s76 offen
    s_add_u32 s87, s87, 131072
    s_cmp_ge_u32 s87, 1835008
    s_cselect_b32 s87, 0, s87
    s_cmp_eq_u32 s3, 4
    s_cbranch_scc0 L_ga1
    s_waitcnt vmcnt(12)
    s_mov_b64 exec, 0x7f7f
    v_cmp_ne_u32 vcc, s68, v52
    s_mov_b64 exec, -1
    s_cmp_lg_u64 vcc, 0
    s_cselect_b32 s23, 1, 0
    s_lshl_b32 s76, s23, 30
    v_mov_b32 v14, 4148
    v_mov_b32 v15, s76
    s_mov_b64 exec, 1
    ds_write_b32 v14, v15
    s_mov_b64 exec, -1
    s_waitcnt lgkmcnt(0)
L_ga1:
    s_barrier
    s_add_u32 m0, s70, 106496
    s_add_u32 s76, s71, s86
    buffer_load_dwordx4 v240, s[52:55], s76 offen lds
    s_add_u32 m0, s70, 110592
    s_add_u32 s76, s76, 32768
    buffer_load_dwordx4 v240, s[52:55], s76 offen lds
    s_add_u32 s86, s86, 131072
    s_cmp_ge_u32 s86, 1835008
    s_cselect_b32 s86, 0, s86
    s_waitcnt vmcnt(12)
    s_cmp_eq_u32 s3, 7
    s_cbranch_scc0 L_nep
    s_cmp_eq_u32 s2, 255
    s_cbranch_scc0 L_nep
    s_mov_b32 s77, 38912
    v_lshlrev_b32 v14, 2, v1
    s_mov_b64 exec, 0xffff
    s_mov_b32 s88, 0
L_gg:
    buffer_load_dword v15, v14, s[60:63], s77 offen sc1
    s_add_u32 s88, s88, 1
    s_cmp_gt_u32 s88, 0x40000
    s_cbranch_scc1 L_gg_x
    s_waitcnt vmcnt(0)
    v_cmp_ne_u32 vcc, s68, v15
    s_cbranch_vccz L_gg_x
    s_sleep 1
    s_branch L_gg
L_gg_x:
    s_mov_b64 exec, -1
    s_mov_b32 s77, 0
    v_mov_b32 v14, 0
    v_mov_b32 v15, s68
    s_mov_b64 exec, 1
    buffer_store_dword v15, v14, s[60:63], s77 offen sc1
    s_mov_b64 exec, -1
L_nep:
    s_cmp_eq_u32 s23, 0
    s_cbranch_scc1 L_ga2
    s_cmp_eq_u32 s3, 4
    s_cbranch_scc0 L_GA_n
    s_lshl_b32 s77, s73, 8
    s_add_u32 s77, s77, s89
    s_add_u32 s77, s77, 768
    v_and_b32 v14, 7, v1
    v_lshrrev_b32 v15, 3, v1
    v_lshlrev_b32 v15, 7, v15
    v_lshl_add_u32 v14, v14, 2, v15
    s_mov_b64 exec, 0x7f7f
    s_mov_b32 s88, 0
L_GA:
    buffer_load_dword v15, v14, s[60:63], s77 offen sc1
    s_add_u32 s88, s88, 1
    s_cmp_gt_u32 s88, 0x40000
    s_cbranch_scc1 L_GA_x
    s_waitcnt vmcnt(0)
    v_cmp_ne_u32 vcc, s68, v15
    s_cbranch_vccz L_GA_x
    s_sleep 1
    s_branch L_GA
L_GA_x:
    s_mov_b64 exec, -1
L_GA_n:
L_ga2:
    s_barrier
    s_setprio 0
    s_add_u32 s76, s70, 114688
    v_add_u32 v14, s76, v8
    ds_write_b128 v14, v[64:67]
    ds_write_b128 v14, v[68:71] offset:4096
    s_waitcnt vmcnt(4)
    s_add_u32 s76, s70, 122880
    v_add_u32 v14, s76, v8
    ds_write_b128 v14, v[72:75]
    ds_write_b128 v14, v[76:79] offset:4096
    s_waitcnt vmcnt(2)
    s_add_u32 s76, s70, 131072
    v_add_u32 v14, s76, v8
    ds_write_b128 v14, v[80:83]
    ds_write_b128 v14, v[84:87] offset:4096
    s_add_u32 s86, s86, 131072
    s_cmp_ge_u32 s86, 1835008
    s_cselect_b32 s86, 0, s86
    s_add_u32 s86, s86, 131072
    s_cmp_ge_u32 s86, 1835008
    s_cselect_b32 s86, 0, s86
    s_add_u32 s86, s86, 131072
    s_cmp_ge_u32 s86, 1835008
    s_cselect_b32 s86, 0, s86
    s_waitcnt lgkmcnt(0)
    s_barrier
    s_cmp_eq_u32 s3, 5
    s_cbranch_scc0 L_nfb
    s_cmp_lt_u32 s57, 14
    s_cbranch_scc0 L_nfb
    s_and_b32 s77, s2, 1
    s_mul_i32 s77, s77, 100
    s_lshl_b32 s78, s57, 2
    s_add_u32 s77, s77, s78
    s_add_u32 s77, s77, s58
    s_add_u32 s77, s77, 1280
    v_lshlrev_b32 v14, 8, v1
    v_mov_b32 v15, s68
    s_mov_b64 exec, 3
    buffer_store_dword v15, v14, s[60:63], s77 offen sc1
    s_mov_b64 exec, -1
L_nfb:
    s_add_u32 m0, s70, 0
    s_add_u32 s76, s71, s86
    s_add_u32 s76, s76, 65536
    buffer_load_dwordx4 v240, s[52:55], s76 offen lds
    s_add_u32 m0, s70, 4096
    s_add_u32 s76, s76, 32768
    buffer_load_dwordx4 v240, s[52:55], s76 offen lds
    s_add_u32 s86, s86, 131072
    s_cmp_ge_u32 s86, 1835008
    s_cselect_b32 s86, 0, s86
    s_add_u32 m0, s70, 8192
    s_add_u32 s76, s71, s86
    s_add_u32 s76, s76, 65536
    buffer_load_dwordx4 v240, s[52:55], s76 offen lds
    s_add_u32 m0, s70, 12288
    s_add_u32 s76, s76, 32768
    buffer_load_dwordx4 v240, s[52:55], s76 offen lds
    s_add_u32 s86, s86, 131072
    s_cmp_ge_u32 s86, 1835008
    s_cselect_b32 s86, 0, s86
    s_add_u32 m0, s70, 16384
    s_add_u32 s76, s71, s86
    s_add_u32 s76, s76, 65536
    buffer_load_dwordx4 v240, s[52:55], s76 offen lds
    s_add_u32 m0, s70, 20480
    s_add_u32 s76, s76, 32768
    buffer_load_dwordx4 v240, s[52:55], s76 offen lds
    s_add_u32 s86, s86, 131072
    s_cmp_ge_u32 s86, 1835008
    s_cselect_b32 s86, 0, s86
    s_add_u32 m0, s70, 24576
    s_add_u32 s76, s71, s86
    s_add_u32 s76, s76, 65536
    buffer_load_dwordx4 v240, s[52:55], s76 offen lds
    s_add_u32 m0, s70, 28672
    s_add_u32 s76, s76, 32768
    buffer_load_dwordx4 v240, s[52:55], s76 offen lds
    s_add_u32 s86, s86, 131072
    s_cmp_ge_u32 s86, 1835008
    s_cselect_b32 s86, 0, s86
    s_waitcnt vmcnt(8)
    s_waitcnt lgkmcnt(0)
    s_barrier
    s_add_u32 m0, s70, 32768
    s_add_u32 s76, s71, s86
    s_add_u32 s76, s76, 65536
    buffer_load_dwordx4 v240, s[52:55], s76 offen lds
    s_add_u32 m0, s70, 36864
    s_add_u32 s76, s76, 32768
    buffer_load_dwordx4 v240, s[52:55], s76 offen lds
    s_add_u32 s86, s86, 131072
    s_cmp_ge_u32 s86, 1835008
    s_cselect_b32 s86, 0, s86
    s_add_u32 m0, s70, 40960
    s_add_u32 s76, s71, s86
    s_add_u32 s76, s76, 65536
    buffer_load_dwordx4 v240, s[52:55], s76 offen lds
    s_add_u32 m0, s70, 45056
    s_add_u32 s76, s76, 32768
    buffer_load_dwordx4 v240, s[52:55], s76 offen lds
    s_add_u32 s86, s86, 131072
    s_cmp_ge_u32 s86, 1835008
    s_cselect_b32 s86, 0, s86
    s_add_u32 m0, s70, 49152
    s_add_u32 s76, s71, s86
    s_add_u32 s76, s76, 65536
    buffer_load_dwordx4 v240, s[52:55], s76 offen lds
    s_add_u32 m0, s70, 53248
    s_add_u32 s76, s76, 32768
    buffer_load_dwordx4 v240, s[52:55], s76 offen lds
    s_add_u32 s86, s86, 131072
    s_cmp_ge_u32 s86, 1835008
    s_cselect_b32 s86, 0, s86
    s_add_u32 m0, s70, 57344
    s_add_u32 s76, s71, s86
    s_add_u32 s76, s76, 65536
    buffer_load_dwordx4 v240, s[52:55], s76 offen lds
    s_add_u32 m0, s70, 61440
    s_add_u32 s76, s76, 32768
    buffer_load_dwordx4 v240, s[52:55], s76 offen lds
    s_add_u32 s86, s86, 131072
    s_cmp_ge_u32 s86, 1835008
    s_cselect_b32 s86, 0, s86
    s_waitcnt vmcnt(14)
    s_waitcnt lgkmcnt(0)
    s_barrier
    s_add_u32 m0, s70, 139264
    s_add_u32 s76, s71, s86
    s_add_u32 s76, s76, 65536
    buffer_load_dwordx4 v240, s[52:55], s76 offen lds
    s_add_u32 m0, s70, 143360
    s_add_u32 s76, s76, 32768
    buffer_load_dwordx4 v240, s[52:55], s76 offen lds
    s_add_u32 s86, s86, 131072
    s_cmp_ge_u32 s86, 1835008
    s_cselect_b32 s86, 0, s86
    s_add_u32 m0, s70, 147456
    s_add_u32 s76, s71, s86
    s_add_u32 s76, s76, 65536
    buffer_load_dwordx4 v240, s[52:55], s76 offen lds
    s_add_u32 m0, s70, 151552
    s_add_u32 s76, s76, 32768
    buffer_load_dwordx4 v240, s[52:55], s76 offen lds
    s_add_u32 s86, s86, 131072
    s_cmp_ge_u32 s86, 1835008
    s_cselect_b32 s86, 0, s86
    s_add_u32 m0, s70, 65536
    s_add_u32 s76, s71, s86
    s_add_u32 s76, s76, 65536
    buffer_load_dwordx4 v240, s[52:55], s76 offen lds
    s_add_u32 m0, s70, 69632
    s_add_u32 s76, s76, 32768
    buffer_load_dwordx4 v240, s[52:55], s76 offen lds
    s_add_u32 s86, s86, 131072
    s_cmp_ge_u32 s86, 1835008
    s_cselect_b32 s86, 0, s86
    s_add_u32 m0, s70, 73728
    s_add_u32 s76, s71, s86
    s_add_u32 s76, s76, 65536
    buffer_load_dwordx4 v240, s[52:55], s76 offen lds
    s_add_u32 m0, s70, 77824
    s_add_u32 s76, s76, 32768
    buffer_load_dwordx4 v240, s[52:55], s76 offen lds
    s_add_u32 s86, s86, 131072
    s_cmp_ge_u32 s86, 1835008
    s_cselect_b32 s86, 0, s86
    s_waitcnt vmcnt(14)
    s_waitcnt lgkmcnt(0)
    s_cmp_eq_u32 s3, 4
    s_cbranch_scc0 L_GB_n
    s_lshl_b32 s77, s73, 8
    s_add_u32 s77, s77, s89
    s_add_u32 s77, s77, 1280
    v_and_b32 v14, 7, v1
    v_lshrrev_b32 v15, 3, v1
    v_lshlrev_b32 v15, 7, v15
    v_lshl_add_u32 v14, v14, 2, v15
    s_mov_b64 exec, 0x7f7f
    s_mov_b32 s88, 0
L_GB:
    buffer_load_dword v15, v14, s[60:63], s77 offen sc1
    s_add_u32 s88, s88, 1
    s_cmp_gt_u32 s88, 0x40000
    s_cbranch_scc1 L_GB_x
    s_waitcnt vmcnt(0)
    v_cmp_ne_u32 vcc, s68, v15
    s_cbranch_vccz L_GB_x
    s_sleep 1
    s_branch L_GB
L_GB_x:
    s_mov_b64 exec, -1
L_GB_n:
    s_barrier
    s_add_u32 m0, s70, 81920
    s_add_u32 s76, s71, s86
    s_add_u32 s76, s76, 65536
    buffer_load_dwordx4 v240, s[52:55], s76 offen lds
    s_add_u32 m0, s70, 86016
    s_add_u32 s76, s76, 32768
    buffer_load_dwordx4 v240, s[52:55], s76 offen lds
    s_add_u32 s86, s86, 131072
    s_cmp_ge_u32 s86, 1835008
    s_cselect_b32 s86, 0, s86
    s_waitcnt vmcnt(8)
    s_waitcnt lgkmcnt(0)
    s_barrier
    s_waitcnt vmcnt(0)
    s_waitcnt lgkmcnt(0)
    s_barrier
    s_waitcnt lgkmcnt(0)
    s_barrier
    s_barrier
L_fin:
L_end:
    s_endpgm
L_codeend:
.section .rodata,"a"
.p2align 6
.amdhsa_kernel adaLN_cond__sliding_local_dilated__glu_gated_bilinear__prompt_kernel
.amdhsa_next_free_vgpr 256
.amdhsa_next_free_sgpr 102
.amdhsa_accum_offset 256
.amdhsa_group_segment_fixed_size 0
.amdhsa_kernarg_size 96
.amdhsa_user_sgpr_count 2
.amdhsa_user_sgpr_kernarg_segment_ptr 1
.amdhsa_system_sgpr_workgroup_id_x 1
.end_amdhsa_kernel
```
